```python
import torch

def _softmax(x, axis=-1):
    return torch.softmax(x, dim=axis)
def _gelu(x):
    return torch.nn.functional.gelu(x, approximate="tanh")
def _silu(x):
    return torch.nn.functional.silu(x)
def _sigmoid(x):
    return torch.sigmoid(x)
def _layernorm(x, axis=-1, eps=1e-5):
    m = x.mean(dim=axis, keepdim=True)
    v = x.var(dim=axis, keepdim=True, unbiased=False)
    return (x - m) / torch.sqrt(v + eps)
def _scatter_add(tgt, idx, src, axis=0):
    return tgt.clone().index_add_(axis, idx, src)
def _segment_sum(src, seg, n):
    out = torch.zeros((n,) + src.shape[1:], dtype=src.dtype)
    return out.index_add_(0, seg, src)
def _pad(x, pw):
    flat = tuple(v for pair in reversed(pw) for v in pair)
    return torch.nn.functional.pad(x, flat)

kernel_name = 'gated_mix__sliding_local_dilated__dense_activation_squared_relu__prompt'

def setup_inputs():

    _w = (lambda a: (lambda t: t.to(torch.bfloat16) if t.is_floating_point() else t)(torch.as_tensor(a)))
    def _A_setup():
        B, S, D = 1, 2048, 640
        return {
            "x": _w((lambda *s: torch.randn(*s, dtype=torch.bfloat16) * 0.05)(B, S, D)),
            "wqkv": _w((lambda *s: torch.randn(*s, dtype=torch.bfloat16) * 0.8)(D, 3 * D)),
            "wo": _w((lambda *s: torch.randn(*s, dtype=torch.bfloat16) * 0.05)(D, D)),
        }
    _A_in = _A_setup()

    def _B_setup():
        B, S, D, F = 1, 2048, 640, 1728
        return {
            "x": _w((lambda *s: torch.randn(*s, dtype=torch.bfloat16) * 0.05)(B, S, D)),
            "w1": _w((lambda *s: torch.randn(*s, dtype=torch.bfloat16) * 0.2)(D, F)),
            "b1": _w((lambda *s: torch.randn(*s, dtype=torch.bfloat16) * 0.2)(F)),
            "w2": _w((lambda *s: torch.randn(*s, dtype=torch.bfloat16) * 0.2)(F, D)),
            "b2": _w((lambda *s: torch.randn(*s, dtype=torch.bfloat16) * 0.2)(D)),
        }
    _B_in = _B_setup()

    return {
        "A_x": _A_in["x"],
        "A_wqkv": _A_in["wqkv"],
        "A_wo": _A_in["wo"],
        "B_x": _B_in["x"],
        "B_w1": _B_in["w1"],
        "B_b1": _B_in["b1"],
        "B_w2": _B_in["w2"],
        "B_b2": _B_in["b2"],
        "gate_w": _w((lambda *s: torch.randn(*s, dtype=torch.bfloat16) * 0.05)(640) * 16.0),
    }

def reference(A_x, A_wqkv, A_wo, B_x, B_w1, B_b1, B_w2, B_b2, gate_w):
    def _A_ref(x, wqkv, wo):
        B, S, D = x.shape
        H = 32; Dh = D // H
        W, dil = 8, 2
        qkv = (lambda x, *d: x.permute(*d))((x @ wqkv).reshape(B, S, 3, H, Dh), 2, 0, 3, 1, 4)
        q, k, v = qkv[0], qkv[1], qkv[2]
        scale = Dh ** -0.5
        pos = torch.arange(S)
        off = torch.arange(W) * dil
        idx = pos[:, None] - off[None, :]
        mask = idx >= 0
        idx_c = torch.where(mask, idx, 0).reshape(-1)
        kg = k[:, :, idx_c, :].reshape(B, H, S, W, Dh)
        vg = v[:, :, idx_c, :].reshape(B, H, S, W, Dh)
        logits = torch.einsum("bhsd,bhswd->bhsw", q, kg) * scale
        logits = torch.where(mask[None, None, :, :], logits, -1e9)
        attn = _softmax(logits, axis=-1)
        o = torch.einsum("bhsw,bhswd->bhsd", attn, vg)
        return (lambda x, *d: x.permute(*d))(o, 0, 2, 1, 3).reshape(B, S, D) @ wo

    def _B_ref(x, w1, b1, w2, b2):
        h = torch.einsum("bsd,df->bsf", x, w1) + b1
        zero = torch.zeros_like(h)
        r = torch.where(h > zero, h, zero)
        h = r * r
        out = torch.einsum("bsf,fd->bsd", h, w2) + b2
        return out

    x = A_x
    g = _sigmoid((x * gate_w).sum(-1, keepdims=True))
    a = _A_ref(x, A_wqkv, A_wo)
    b = _B_ref(x, B_w1, B_b1, B_w2, B_b2)
    return g * a + (1 - g) * b
```

```asm
; @launch grid=(256,1,1) block=(256,1,1) lds=163840
.amdgcn_target "amdgcn-amd-amdhsa--gfx950"
.text
.globl gated_mix__sliding_local_dilated__dense_activation_squared_relu__prompt_kernel
.p2align 8
.type gated_mix__sliding_local_dilated__dense_activation_squared_relu__prompt_kernel,@function
gated_mix__sliding_local_dilated__dense_activation_squared_relu__prompt_kernel:
    s_cmp_ge_u32 s2, 256
    s_cbranch_scc1 L_end
    s_load_dwordx4 s[68:71], s[0:1], 0
    s_load_dwordx2 s[72:73], s[0:1], 16
    s_load_dwordx4 s[76:79], s[0:1], 32
    s_load_dwordx4 s[80:83], s[0:1], 48
    s_load_dwordx4 s[84:87], s[0:1], 64
    s_load_dwordx4 s[88:91], s[0:1], 80
    v_and_b32 v1, 63, v0
    v_lshrrev_b32 v2, 6, v0
    s_and_b32 s3, s2, 7
    s_lshr_b32 s62, s2, 3
    v_readfirstlane_b32 s50, v2
    s_lshr_b32 s51, s3, 1
    s_lshl_b32 s51, s51, 2
    s_lshr_b32 s61, s62, 2
    s_and_b32 s61, s61, 3
    s_add_u32 s51, s51, s61
    s_and_b32 s52, s3, 1
    s_lshl_b32 s52, s52, 2
    s_and_b32 s61, s62, 3
    s_add_u32 s52, s52, s61
    s_lshr_b32 s95, s3, 1
    s_lshl_b32 s95, s95, 3
    s_lshr_b32 s61, s62, 2
    s_add_u32 s95, s95, s61
    s_and_b32 s96, s3, 1
    s_lshl_b32 s96, s96, 2
    s_and_b32 s61, s62, 3
    s_add_u32 s96, s96, s61
    s_cmp_lg_u32 s50, 0
    s_cbranch_scc1 L_pfc_skip
    s_getpc_b64 s[4:5]
L_pfc_pc:
    s_sub_u32 s4, s4, L_pfc_pc-gated_mix__sliding_local_dilated__dense_activation_squared_relu__prompt_kernel
    s_subb_u32 s5, s5, 0
    s_lshr_b32 s6, s2, 3
    s_lshl_b32 s6, s6, 11
    v_lshlrev_b32 v2, 7, v1
    v_add_u32 v2, s6, v2
    v_cmp_gt_u32 vcc, 16, v1
    s_nop 1
    v_cndmask_b32 v2, -1, v2, vcc
    v_cmp_gt_u32 vcc, L_end-gated_mix__sliding_local_dilated__dense_activation_squared_relu__prompt_kernel, v2
    s_nop 4
    s_and_saveexec_b64 s[6:7], vcc
    s_cbranch_execz L_pfc_none
    global_load_dword v160, v2, s[4:5]
L_pfc_none:
    s_mov_b64 exec, s[6:7]
L_pfc_skip:
    s_cmp_ge_u32 s2, 128
    s_cbranch_scc1 L_role_h
L_role_q:
    v_and_b32 v16, 15, v1
    v_lshrrev_b32 v17, 4, v1
    v_lshrrev_b32 v18, 1, v16
    v_xor_b32 v18, v18, v17
    v_lshlrev_b32 v18, 4, v18
    v_lshl_add_u32 v240, v16, 7, v18
    v_add_u32 v240, 30720, v240
    v_xor_b32 v241, 64, v240
    v_lshrrev_b32 v19, 1, v17
    v_lshlrev_b32 v19, 4, v19
    v_and_b32 v17, 1, v17
    v_lshl_add_u32 v19, v17, 2, v19
    v_lshrrev_b32 v18, 2, v16
    v_add_u32 v19, v19, v18
    v_mul_u32_u24 v19, 480, v19
    v_and_b32 v16, 3, v1
    v_lshl_add_u32 v242, v16, 3, v19
    s_mul_i32 s63, s52, 160
    s_lshl_b32 s61, s50, 6
    v_add_u32 v24, s61, v1
    v_mul_u32_u24 v17, 2185, v24
    v_lshrrev_b32 v17, 16, v17
    v_mul_u32_u24 v18, 30, v17
    v_sub_u32 v18, v24, v18
    v_mul_u32_u24 v19, 6554, v18
    v_lshrrev_b32 v19, 16, v19
    v_mul_u32_u24 v20, 1120, v19
    v_lshl_add_u32 v18, v18, 4, v20
    v_and_b32 v19, 0x73, v17
    v_and_b32 v20, 4, v17
    v_lshl_add_u32 v19, v20, 1, v19
    v_and_b32 v20, 8, v17
    v_lshrrev_b32 v20, 1, v20
    v_add_u32 v19, v19, v20
    v_mul_u32_u24 v19, 3840, v19
    v_add3_u32 v4, v19, v18, s63
    v_add_u32 v24, 256, v24
    v_mul_u32_u24 v17, 2185, v24
    v_lshrrev_b32 v17, 16, v17
    v_mul_u32_u24 v18, 30, v17
    v_sub_u32 v18, v24, v18
    v_mul_u32_u24 v19, 6554, v18
    v_lshrrev_b32 v19, 16, v19
    v_mul_u32_u24 v20, 1120, v19
    v_lshl_add_u32 v18, v18, 4, v20
    v_and_b32 v19, 0x73, v17
    v_and_b32 v20, 4, v17
    v_lshl_add_u32 v19, v20, 1, v19
    v_and_b32 v20, 8, v17
    v_lshrrev_b32 v20, 1, v20
    v_add_u32 v19, v19, v20
    v_mul_u32_u24 v19, 3840, v19
    v_add3_u32 v5, v19, v18, s63
    v_add_u32 v24, 256, v24
    v_mul_u32_u24 v17, 2185, v24
    v_lshrrev_b32 v17, 16, v17
    v_mul_u32_u24 v18, 30, v17
    v_sub_u32 v18, v24, v18
    v_mul_u32_u24 v19, 6554, v18
    v_lshrrev_b32 v19, 16, v19
    v_mul_u32_u24 v20, 1120, v19
    v_lshl_add_u32 v18, v18, 4, v20
    v_and_b32 v19, 0x73, v17
    v_and_b32 v20, 4, v17
    v_lshl_add_u32 v19, v20, 1, v19
    v_and_b32 v20, 8, v17
    v_lshrrev_b32 v20, 1, v20
    v_add_u32 v19, v19, v20
    v_mul_u32_u24 v19, 3840, v19
    v_add3_u32 v6, v19, v18, s63
    v_add_u32 v24, 256, v24
    v_mul_u32_u24 v17, 2185, v24
    v_lshrrev_b32 v17, 16, v17
    v_mul_u32_u24 v18, 30, v17
    v_sub_u32 v18, v24, v18
    v_mul_u32_u24 v19, 6554, v18
    v_lshrrev_b32 v19, 16, v19
    v_mul_u32_u24 v20, 1120, v19
    v_lshl_add_u32 v18, v18, 4, v20
    v_and_b32 v19, 0x73, v17
    v_and_b32 v20, 4, v17
    v_lshl_add_u32 v19, v20, 1, v19
    v_and_b32 v20, 8, v17
    v_lshrrev_b32 v20, 1, v20
    v_add_u32 v19, v19, v20
    v_mul_u32_u24 v19, 3840, v19
    v_add3_u32 v7, v19, v18, s63
    v_add_u32 v24, 256, v24
    v_mul_u32_u24 v17, 2185, v24
    v_lshrrev_b32 v17, 16, v17
    v_mul_u32_u24 v18, 30, v17
    v_sub_u32 v18, v24, v18
    v_mul_u32_u24 v19, 6554, v18
    v_lshrrev_b32 v19, 16, v19
    v_mul_u32_u24 v20, 1120, v19
    v_lshl_add_u32 v18, v18, 4, v20
    v_and_b32 v19, 0x73, v17
    v_and_b32 v20, 4, v17
    v_lshl_add_u32 v19, v20, 1, v19
    v_and_b32 v20, 8, v17
    v_lshrrev_b32 v20, 1, v20
    v_add_u32 v19, v19, v20
    v_mul_u32_u24 v19, 3840, v19
    v_add3_u32 v8, v19, v18, s63
    v_add_u32 v24, 256, v24
    v_mul_u32_u24 v17, 2185, v24
    v_lshrrev_b32 v17, 16, v17
    v_mul_u32_u24 v18, 30, v17
    v_sub_u32 v18, v24, v18
    v_mul_u32_u24 v19, 6554, v18
    v_lshrrev_b32 v19, 16, v19
    v_mul_u32_u24 v20, 1120, v19
    v_lshl_add_u32 v18, v18, 4, v20
    v_and_b32 v19, 0x73, v17
    v_and_b32 v20, 4, v17
    v_lshl_add_u32 v19, v20, 1, v19
    v_and_b32 v20, 8, v17
    v_lshrrev_b32 v20, 1, v20
    v_add_u32 v19, v19, v20
    v_mul_u32_u24 v19, 3840, v19
    v_add3_u32 v9, v19, v18, s63
    v_add_u32 v24, 256, v24
    v_mul_u32_u24 v17, 2185, v24
    v_lshrrev_b32 v17, 16, v17
    v_mul_u32_u24 v18, 30, v17
    v_sub_u32 v18, v24, v18
    v_mul_u32_u24 v19, 6554, v18
    v_lshrrev_b32 v19, 16, v19
    v_mul_u32_u24 v20, 1120, v19
    v_lshl_add_u32 v18, v18, 4, v20
    v_and_b32 v19, 0x73, v17
    v_and_b32 v20, 4, v17
    v_lshl_add_u32 v19, v20, 1, v19
    v_and_b32 v20, 8, v17
    v_lshrrev_b32 v20, 1, v20
    v_add_u32 v19, v19, v20
    v_mul_u32_u24 v19, 3840, v19
    v_add3_u32 v10, v19, v18, s63
    v_add_u32 v24, 256, v24
    v_mul_u32_u24 v17, 2185, v24
    v_lshrrev_b32 v17, 16, v17
    v_mul_u32_u24 v18, 30, v17
    v_sub_u32 v18, v24, v18
    v_mul_u32_u24 v19, 6554, v18
    v_lshrrev_b32 v19, 16, v19
    v_mul_u32_u24 v20, 1120, v19
    v_lshl_add_u32 v18, v18, 4, v20
    v_and_b32 v19, 0x73, v17
    v_and_b32 v20, 4, v17
    v_lshl_add_u32 v19, v20, 1, v19
    v_and_b32 v20, 8, v17
    v_lshrrev_b32 v20, 1, v20
    v_add_u32 v19, v19, v20
    v_mul_u32_u24 v19, 3840, v19
    v_add3_u32 v11, v19, v18, s63
    s_lshl_b32 s61, s51, 7
    s_lshl_b32 s62, s50, 3
    s_add_u32 s61, s61, s62
    s_sub_u32 s61, s61, 16
    s_mul_i32 s61, s61, 1280
    s_and_b32 s15, s50, 1
    s_lshl_b32 s15, s15, 2
    v_lshrrev_b32 v16, 4, v1
    v_add_u32 v16, s15, v16
    v_xor_b32 v16, v16, v1
    v_and_b32 v16, 7, v16
    v_lshrrev_b32 v17, 3, v1
    v_mul_u32_u24 v17, 1280, v17
    v_lshl_add_u32 v17, v16, 4, v17
    v_add_u32 v12, s61, v17
    v_add_u32 v13, 40960, v12
    v_add_u32 v14, 81920, v12
    v_add_u32 v15, 122880, v12
    s_waitcnt lgkmcnt(0)
    s_mov_b32 s16, s68
    s_and_b32 s17, s69, 0xffff
    s_mov_b32 s18, 2621440
    s_mov_b32 s19, 0x20000
    s_mov_b32 s20, s70
    s_and_b32 s21, s71, 0xffff
    s_mov_b32 s22, 2457600
    s_mov_b32 s23, 0x20000
    s_mov_b32 s64, 2621440
    s_mov_b32 s65, 2457600
    s_mov_b32 s61, 28672
    s_mov_b32 s62, 245760
    s_cmp_ge_u32 s50, 2
    s_cselect_b32 s24, s16, s20
    s_cselect_b32 s25, s17, s21
    s_cselect_b32 s26, s18, s22
    s_mov_b32 s27, 0x20000
    s_cselect_b32 s66, s64, s65
    s_cselect_b32 s59, 128, s62
    s_cselect_b32 s58, 45056, s61
    s_cselect_b64 vcc, -1, 0
    v_add_u32 v16, 143360, v12
    v_cndmask_b32 v11, v11, v16, vcc
    s_lshl_b32 s67, s50, 10
    s_mov_b32 s53, 0
    s_mov_b32 s60, 0
    s_and_b32 s14, s51, 1
    s_xor_b32 s61, s14, 0
    s_mul_i32 s55, s61, 245760
    s_lshl_b32 s56, s61, 7
    s_mul_i32 s57, s61, s59
    s_mov_b32 s54, s67
    s_add_u32 m0, s54, 0
    s_nop 0
    buffer_load_dwordx4 v4, s[20:23], s55 offen lds
    s_add_u32 m0, s54, 4096
    s_nop 0
    buffer_load_dwordx4 v5, s[20:23], s55 offen lds
    s_add_u32 m0, s54, 30720
    s_nop 0
    buffer_load_dwordx4 v12, s[16:19], s56 offen lds
    s_add_u32 m0, s54, 8192
    s_nop 0
    buffer_load_dwordx4 v6, s[20:23], s55 offen lds
    s_add_u32 m0, s54, 34816
    s_nop 0
    buffer_load_dwordx4 v13, s[16:19], s56 offen lds
    s_add_u32 m0, s54, 12288
    s_nop 0
    buffer_load_dwordx4 v7, s[20:23], s55 offen lds
    s_add_u32 m0, s54, 16384
    s_nop 0
    buffer_load_dwordx4 v8, s[20:23], s55 offen lds
    s_add_u32 m0, s54, 20480
    s_nop 0
    buffer_load_dwordx4 v9, s[20:23], s55 offen lds
    s_add_u32 m0, s54, 38912
    s_nop 0
    buffer_load_dwordx4 v14, s[16:19], s56 offen lds
    s_add_u32 m0, s54, 24576
    s_nop 0
    buffer_load_dwordx4 v10, s[20:23], s55 offen lds
    s_add_u32 m0, s54, s58
    s_nop 0
    buffer_load_dwordx4 v11, s[24:27], s57 offen lds
    s_add_u32 m0, s54, 43008
    s_nop 0
    buffer_load_dwordx4 v15, s[16:19], s56 offen lds
    s_xor_b32 s61, s14, 1
    s_mul_i32 s55, s61, 245760
    s_lshl_b32 s56, s61, 7
    s_mul_i32 s57, s61, s59
    s_add_u32 s54, s67, 49152
    s_add_u32 m0, s54, 0
    s_nop 0
    buffer_load_dwordx4 v4, s[20:23], s55 offen lds
    s_add_u32 m0, s54, 4096
    s_nop 0
    buffer_load_dwordx4 v5, s[20:23], s55 offen lds
    s_add_u32 m0, s54, 30720
    s_nop 0
    buffer_load_dwordx4 v12, s[16:19], s56 offen lds
    s_add_u32 m0, s54, 8192
    s_nop 0
    buffer_load_dwordx4 v6, s[20:23], s55 offen lds
    s_add_u32 m0, s54, 34816
    s_nop 0
    buffer_load_dwordx4 v13, s[16:19], s56 offen lds
    s_add_u32 m0, s54, 12288
    s_nop 0
    buffer_load_dwordx4 v7, s[20:23], s55 offen lds
    s_add_u32 m0, s54, 16384
    s_nop 0
    buffer_load_dwordx4 v8, s[20:23], s55 offen lds
    s_add_u32 m0, s54, 20480
    s_nop 0
    buffer_load_dwordx4 v9, s[20:23], s55 offen lds
    s_add_u32 m0, s54, 38912
    s_nop 0
    buffer_load_dwordx4 v14, s[16:19], s56 offen lds
    s_add_u32 m0, s54, 24576
    s_nop 0
    buffer_load_dwordx4 v10, s[20:23], s55 offen lds
    s_add_u32 m0, s54, s58
    s_nop 0
    buffer_load_dwordx4 v11, s[24:27], s57 offen lds
    s_add_u32 m0, s54, 43008
    s_nop 0
    buffer_load_dwordx4 v15, s[16:19], s56 offen lds
    s_xor_b32 s61, s14, 2
    s_mul_i32 s55, s61, 245760
    s_lshl_b32 s56, s61, 7
    s_mul_i32 s57, s61, s59
    s_add_u32 s54, s67, 98304
    s_lshl_b32 s63, s51, 3
    s_add_u32 s63, s63, s52
    s_mul_i32 s61, s63, 14336
    s_lshl_b32 s62, s50, 10
    s_add_u32 s61, s61, s62
    s_add_u32 s61, s61, 737280
    v_lshlrev_b32 v212, 4, v1
    v_add_u32 v212, s61, v212
    s_mov_b32 s28, s90
    s_and_b32 s29, s91, 0xffff
    s_mov_b32 s30, 9699328
    s_mov_b32 s31, 0x20000
    s_add_u32 s32, s90, 9830400
    s_addc_u32 s33, s91, 0
    s_and_b32 s33, s33, 0xffff
    s_mov_b32 s34, 3031040
    s_mov_b32 s35, 0x20000
    s_mov_b32 s44, s86
    s_and_b32 s45, s87, 0xffff
    s_mov_b32 s46, 2621440
    s_mov_b32 s47, 0x20000
    s_mov_b64 s[48:49], s[88:89]
    s_mov_b32 s68, 0xaaaaaaaa
    s_mov_b32 s69, 0xaaaaaaaa
    s_mov_b32 s70, 0xffff
    s_mov_b32 s71, 0x0
    s_mov_b32 s72, 0xffff0000
    s_mov_b32 s73, 0xffffffff
    s_mov_b32 s74, 0xffffffff
    s_mov_b32 s75, 0x0
    s_mov_b32 s76, 0x0
    s_mov_b32 s77, 0xffffffff
    s_mov_b32 s78, 0xffffffff
    s_mov_b32 s79, 0xffff
    s_mov_b32 s80, 0x0
    s_mov_b32 s81, 0xffff0000
    v_and_b32 v248, 15, v1
    v_and_b32 v249, 1, v1
    v_lshrrev_b32 v250, 4, v1
    v_lshl_add_u32 v250, v250, 2, v249
    v_cmp_le_u32 s[82:83], v250, v248
    v_add_u32 v250, 2, v250
    v_cmp_le_u32 s[84:85], v250, v248
    s_or_b32 s61, s51, s50
    s_cmp_eq_u32 s61, 0
    s_cselect_b64 s[86:87], -1, 0
    s_cselect_b64 s[88:89], -1, 0
    s_andn2_b64 s[86:87], s[86:87], s[82:83]
    s_andn2_b64 s[88:89], s[88:89], s[84:85]
    s_lshl_b32 s61, s52, 1
    s_add_u32 s61, s61, 54
    s_lshl_b32 s90, s61, 10
    s_add_u32 s91, s90, 1024
    s_lshr_b32 s61, s52, 1
    s_add_u32 s61, s61, 70
    s_lshl_b32 s61, s61, 10
    s_and_b32 s62, s52, 1
    s_lshl_b32 s62, s62, 9
    s_add_u32 s92, s61, s62
    v_add_u32 v244, s53, v240
    v_add_u32 v246, s53, v242
    v_add_u32 v245, s53, v241
    s_waitcnt vmcnt(12)
    s_barrier
    s_cmp_eq_u32 s50, 1
    s_cbranch_scc1 L_q_wave1
    s_cmp_eq_u32 s50, 2
    s_cbranch_scc1 L_q_wave2
    s_cmp_eq_u32 s50, 3
    s_cbranch_scc1 L_q_wave3
L_q_wave0:
    ds_read_b64_tr_b16 a[40:41], v246 offset:0
    ds_read_b64_tr_b16 a[42:43], v246 offset:3840
    ds_read_b128 a[0:3], v244 offset:2048
    ds_read_b128 a[4:7], v244 offset:4096
    ds_read_b128 a[8:11], v244 offset:6144
    ds_read_b128 a[12:15], v244 offset:8192
    ds_read_b64_tr_b16 a[44:45], v246 offset:32
    ds_read_b64_tr_b16 a[46:47], v246 offset:3872
    ds_read_b64_tr_b16 a[48:49], v246 offset:64
    ds_read_b64_tr_b16 a[50:51], v246 offset:3904
    ds_read_b64_tr_b16 a[52:53], v246 offset:96
    ds_read_b64_tr_b16 a[54:55], v246 offset:3936
    ds_read_b64_tr_b16 a[56:57], v246 offset:128
    ds_read_b64_tr_b16 a[58:59], v246 offset:3968
    ds_read_b128 a[16:19], v244
    ds_read_b64_tr_b16 a[60:61], v246 offset:160
    ds_read_b64_tr_b16 a[62:63], v246 offset:4000
    ds_read_b64_tr_b16 a[64:65], v246 offset:192
    ds_read_b64_tr_b16 a[66:67], v246 offset:4032
    ds_read_b64_tr_b16 a[68:69], v246 offset:224
    ds_read_b64_tr_b16 a[70:71], v246 offset:4064
    s_waitcnt lgkmcnt(15)
    v_mfma_f32_16x16x32_bf16 v[16:19], a[40:43], a[0:3], 0
    s_add_u32 m0, s54, 0
    ds_read_b64_tr_b16 a[72:73], v246 offset:15360
    v_mfma_f32_16x16x32_bf16 v[48:51], a[40:43], a[4:7], 0
    buffer_load_dwordx4 v4, s[20:23], s55 offen lds
    v_mfma_f32_16x16x32_bf16 v[80:83], a[40:43], a[8:11], 0
    s_add_u32 m0, s54, 4096
    ds_read_b64_tr_b16 a[74:75], v246 offset:19200
    v_mfma_f32_16x16x32_bf16 v[112:115], a[40:43], a[12:15], 0
    buffer_load_dwordx4 v5, s[20:23], s55 offen lds
    s_waitcnt lgkmcnt(15)
    v_mfma_f32_16x16x32_bf16 v[20:23], a[44:47], a[0:3], 0
    s_add_u32 m0, s54, 30720
    ds_read_b128 a[20:23], v245 offset:2048
    v_mfma_f32_16x16x32_bf16 v[52:55], a[44:47], a[4:7], 0
    buffer_load_dwordx4 v12, s[16:19], s56 offen lds
    v_mfma_f32_16x16x32_bf16 v[84:87], a[44:47], a[8:11], 0
    s_add_u32 m0, s54, 8192
    ds_read_b128 a[24:27], v245 offset:4096
    v_mfma_f32_16x16x32_bf16 v[116:119], a[44:47], a[12:15], 0
    buffer_load_dwordx4 v6, s[20:23], s55 offen lds
    s_waitcnt lgkmcnt(15)
    v_mfma_f32_16x16x32_bf16 v[24:27], a[48:51], a[0:3], 0
    s_add_u32 m0, s54, 34816
    ds_read_b128 a[28:31], v245 offset:6144
    v_mfma_f32_16x16x32_bf16 v[56:59], a[48:51], a[4:7], 0
    buffer_load_dwordx4 v13, s[16:19], s56 offen lds
    v_mfma_f32_16x16x32_bf16 v[88:91], a[48:51], a[8:11], 0
    s_add_u32 m0, s54, 12288
    ds_read_b128 a[32:35], v245 offset:8192
    v_mfma_f32_16x16x32_bf16 v[120:123], a[48:51], a[12:15], 0
    buffer_load_dwordx4 v7, s[20:23], s55 offen lds
    s_waitcnt lgkmcnt(15)
    v_mfma_f32_16x16x32_bf16 v[28:31], a[52:55], a[0:3], 0
    s_add_u32 m0, s54, 16384
    ds_read_b64_tr_b16 a[76:77], v246 offset:15392
    v_mfma_f32_16x16x32_bf16 v[60:63], a[52:55], a[4:7], 0
    buffer_load_dwordx4 v8, s[20:23], s55 offen lds
    v_mfma_f32_16x16x32_bf16 v[92:95], a[52:55], a[8:11], 0
    ds_read_b64_tr_b16 a[78:79], v246 offset:19232
    v_mfma_f32_16x16x32_bf16 v[124:127], a[52:55], a[12:15], 0
    buffer_load_dwordx4 v[208:211], v212, s[20:23], 0 offen
    v_add_u32 v212, 4096, v212
    s_waitcnt lgkmcnt(15)
    v_mfma_f32_16x16x32_bf16 v[32:35], a[56:59], a[0:3], 0
    buffer_load_dwordx4 v[208:211], v212, s[20:23], 0 offen
    v_mfma_f32_16x16x32_bf16 v[64:67], a[56:59], a[4:7], 0
    v_add_u32 v212, 4096, v212
    ds_read_b64_tr_b16 a[80:81], v246 offset:15424
    v_mfma_f32_16x16x32_bf16 v[96:99], a[56:59], a[8:11], 0
    buffer_load_dwordx4 v[208:211], v212, s[20:23], 0 offen
    v_mfma_f32_16x16x32_bf16 v[128:131], a[56:59], a[12:15], 0
    v_add_u32 v212, 4096, v212
    ds_read_b64_tr_b16 a[82:83], v246 offset:19264
    s_waitcnt lgkmcnt(14)
    v_mfma_f32_16x16x32_bf16 v[36:39], a[60:63], a[0:3], 0
    buffer_load_dwordx4 v[208:211], v212, s[20:23], 0 offen
    v_mfma_f32_16x16x32_bf16 v[68:71], a[60:63], a[4:7], 0
    s_add_u32 m0, s54, 20480
    ds_read_b64_tr_b16 a[84:85], v246 offset:15456
    v_mfma_f32_16x16x32_bf16 v[100:103], a[60:63], a[8:11], 0
    buffer_load_dwordx4 v9, s[20:23], s55 offen lds
    v_mfma_f32_16x16x32_bf16 v[132:135], a[60:63], a[12:15], 0
    s_add_u32 m0, s54, 38912
    ds_read_b64_tr_b16 a[86:87], v246 offset:19296
    v_mfma_f32_16x16x32_bf16 v[144:147], a[60:63], a[16:19], 0
    buffer_load_dwordx4 v14, s[16:19], s56 offen lds
    s_waitcnt lgkmcnt(14)
    v_mfma_f32_16x16x32_bf16 v[40:43], a[64:67], a[0:3], 0
    s_add_u32 m0, s54, 24576
    ds_read_b64_tr_b16 a[88:89], v246 offset:15488
    v_mfma_f32_16x16x32_bf16 v[72:75], a[64:67], a[4:7], 0
    buffer_load_dwordx4 v10, s[20:23], s55 offen lds
    v_mfma_f32_16x16x32_bf16 v[104:107], a[64:67], a[8:11], 0
    s_add_u32 m0, s54, s58
    ds_read_b64_tr_b16 a[90:91], v246 offset:19328
    v_mfma_f32_16x16x32_bf16 v[136:139], a[64:67], a[12:15], 0
    buffer_load_dwordx4 v11, s[24:27], s57 offen lds
    s_waitcnt lgkmcnt(14)
    v_mfma_f32_16x16x32_bf16 v[44:47], a[68:71], a[0:3], 0
    s_add_u32 m0, s54, 43008
    ds_read_b128 a[36:39], v245
    v_mfma_f32_16x16x32_bf16 v[76:79], a[68:71], a[4:7], 0
    buffer_load_dwordx4 v15, s[16:19], s56 offen lds
    v_mfma_f32_16x16x32_bf16 v[108:111], a[68:71], a[8:11], 0
    ds_read_b64_tr_b16 a[92:93], v246 offset:15520
    v_mfma_f32_16x16x32_bf16 v[140:143], a[68:71], a[12:15], 0
    ds_read_b64_tr_b16 a[94:95], v246 offset:19360
    ds_read_b64_tr_b16 a[96:97], v246 offset:15552
    ds_read_b64_tr_b16 a[98:99], v246 offset:19392
    ds_read_b64_tr_b16 a[100:101], v246 offset:15584
    ds_read_b64_tr_b16 a[102:103], v246 offset:19424
    s_add_u32 s54, s53, s67
    s_add_u32 s61, s60, 3
    s_xor_b32 s61, s61, s14
    s_mul_i32 s55, s61, 245760
    s_lshl_b32 s56, s61, 7
    s_mul_i32 s57, s61, s59
    s_cmp_lt_u32 s60, 7
    s_cselect_b32 s22, s65, 0
    s_cselect_b32 s18, s64, 0
    s_cselect_b32 s26, s66, 0
    s_add_u32 s53, s53, 49152
    s_cmp_eq_u32 s53, 147456
    s_cselect_b32 s53, 0, s53
    v_add_u32 v244, s53, v240
    v_add_u32 v246, s53, v242
    v_add_u32 v245, s53, v241
    s_waitcnt lgkmcnt(15)
    s_branch L_q_loop0_B
L_q_loop0:
    s_waitcnt lgkmcnt(15)
    v_mfma_f32_16x16x32_bf16 v[16:19], a[40:43], a[0:3], v[16:19]
    ds_read_b64_tr_b16 a[72:73], v246 offset:15360
    v_mfma_f32_16x16x32_bf16 v[48:51], a[40:43], a[4:7], v[48:51]
    ds_read_b64_tr_b16 a[74:75], v246 offset:19200
    v_mfma_f32_16x16x32_bf16 v[80:83], a[40:43], a[8:11], v[80:83]
    s_add_u32 m0, s54, 20480
    ds_read_b128 a[20:23], v245 offset:2048
    v_mfma_f32_16x16x32_bf16 v[112:115], a[40:43], a[12:15], v[112:115]
    buffer_load_dwordx4 v9, s[20:23], s55 offen lds
    s_waitcnt lgkmcnt(15)
    v_mfma_f32_16x16x32_bf16 v[20:23], a[44:47], a[0:3], v[20:23]
    ds_read_b128 a[24:27], v245 offset:4096
    v_mfma_f32_16x16x32_bf16 v[52:55], a[44:47], a[4:7], v[52:55]
    ds_read_b128 a[28:31], v245 offset:6144
    v_mfma_f32_16x16x32_bf16 v[84:87], a[44:47], a[8:11], v[84:87]
    s_add_u32 m0, s54, 38912
    ds_read_b128 a[32:35], v245 offset:8192
    v_mfma_f32_16x16x32_bf16 v[116:119], a[44:47], a[12:15], v[116:119]
    buffer_load_dwordx4 v14, s[16:19], s56 offen lds
    s_waitcnt lgkmcnt(15)
    v_mfma_f32_16x16x32_bf16 v[24:27], a[48:51], a[0:3], v[24:27]
    ds_read_b64_tr_b16 a[76:77], v246 offset:15392
    v_mfma_f32_16x16x32_bf16 v[56:59], a[48:51], a[4:7], v[56:59]
    ds_read_b64_tr_b16 a[78:79], v246 offset:19232
    v_mfma_f32_16x16x32_bf16 v[88:91], a[48:51], a[8:11], v[88:91]
    s_add_u32 m0, s54, 24576
    ds_read_b64_tr_b16 a[80:81], v246 offset:15424
    v_mfma_f32_16x16x32_bf16 v[120:123], a[48:51], a[12:15], v[120:123]
    buffer_load_dwordx4 v10, s[20:23], s55 offen lds
    v_mfma_f32_16x16x32_bf16 v[28:31], a[52:55], a[0:3], v[28:31]
    ds_read_b64_tr_b16 a[82:83], v246 offset:19264
    v_mfma_f32_16x16x32_bf16 v[60:63], a[52:55], a[4:7], v[60:63]
    ds_read_b64_tr_b16 a[84:85], v246 offset:15456
    v_mfma_f32_16x16x32_bf16 v[92:95], a[52:55], a[8:11], v[92:95]
    s_add_u32 m0, s54, s58
    ds_read_b64_tr_b16 a[86:87], v246 offset:19296
    v_mfma_f32_16x16x32_bf16 v[124:127], a[52:55], a[12:15], v[124:127]
    buffer_load_dwordx4 v11, s[24:27], s57 offen lds
    s_waitcnt lgkmcnt(15)
    v_mfma_f32_16x16x32_bf16 v[32:35], a[56:59], a[0:3], v[32:35]
    ds_read_b64_tr_b16 a[88:89], v246 offset:15488
    v_mfma_f32_16x16x32_bf16 v[64:67], a[56:59], a[4:7], v[64:67]
    ds_read_b64_tr_b16 a[90:91], v246 offset:19328
    v_mfma_f32_16x16x32_bf16 v[96:99], a[56:59], a[8:11], v[96:99]
    s_add_u32 m0, s54, 43008
    ds_read_b128 a[36:39], v245
    v_mfma_f32_16x16x32_bf16 v[128:131], a[56:59], a[12:15], v[128:131]
    buffer_load_dwordx4 v15, s[16:19], s56 offen lds
    v_mfma_f32_16x16x32_bf16 v[36:39], a[60:63], a[0:3], v[36:39]
    ds_read_b64_tr_b16 a[92:93], v246 offset:15520
    v_mfma_f32_16x16x32_bf16 v[68:71], a[60:63], a[4:7], v[68:71]
    ds_read_b64_tr_b16 a[94:95], v246 offset:19360
    v_mfma_f32_16x16x32_bf16 v[100:103], a[60:63], a[8:11], v[100:103]
    ds_read_b64_tr_b16 a[96:97], v246 offset:15552
    v_mfma_f32_16x16x32_bf16 v[132:135], a[60:63], a[12:15], v[132:135]
    ds_read_b64_tr_b16 a[98:99], v246 offset:19392
    v_mfma_f32_16x16x32_bf16 v[144:147], a[60:63], a[16:19], v[144:147]
    ds_read_b64_tr_b16 a[100:101], v246 offset:15584
    s_waitcnt lgkmcnt(15)
    v_mfma_f32_16x16x32_bf16 v[40:43], a[64:67], a[0:3], v[40:43]
    ds_read_b64_tr_b16 a[102:103], v246 offset:19424
    s_add_u32 s54, s53, s67
    v_mfma_f32_16x16x32_bf16 v[72:75], a[64:67], a[4:7], v[72:75]
    s_add_u32 s61, s60, 3
    s_xor_b32 s61, s61, s14
    s_mul_i32 s55, s61, 245760
    v_mfma_f32_16x16x32_bf16 v[104:107], a[64:67], a[8:11], v[104:107]
    s_lshl_b32 s56, s61, 7
    s_mul_i32 s57, s61, s59
    s_cmp_lt_u32 s60, 7
    v_mfma_f32_16x16x32_bf16 v[136:139], a[64:67], a[12:15], v[136:139]
    s_cselect_b32 s22, s65, 0
    s_cselect_b32 s18, s64, 0
    s_cselect_b32 s26, s66, 0
    v_mfma_f32_16x16x32_bf16 v[44:47], a[68:71], a[0:3], v[44:47]
    s_add_u32 s53, s53, 49152
    s_cmp_eq_u32 s53, 147456
    s_cselect_b32 s53, 0, s53
    v_mfma_f32_16x16x32_bf16 v[76:79], a[68:71], a[4:7], v[76:79]
    v_add_u32 v244, s53, v240
    v_mfma_f32_16x16x32_bf16 v[108:111], a[68:71], a[8:11], v[108:111]
    v_add_u32 v246, s53, v242
    v_mfma_f32_16x16x32_bf16 v[140:143], a[68:71], a[12:15], v[140:143]
    v_add_u32 v245, s53, v241
L_q_loop0_B:
    v_mfma_f32_16x16x32_bf16 v[16:19], a[72:75], a[20:23], v[16:19]
    v_mfma_f32_16x16x32_bf16 v[48:51], a[72:75], a[24:27], v[48:51]
    v_mfma_f32_16x16x32_bf16 v[80:83], a[72:75], a[28:31], v[80:83]
    s_waitcnt lgkmcnt(13)
    v_mfma_f32_16x16x32_bf16 v[112:115], a[72:75], a[32:35], v[112:115]
    s_cmp_eq_u32 s60, 0
    s_cbranch_scc1 L_q_alt0
    s_waitcnt vmcnt(12) lgkmcnt(0)
L_q_alt_ret0:
    s_barrier
    s_cmp_eq_u32 s60, 9
    s_cbranch_scc1 L_q_hook
L_q_hook_ret:
    v_mfma_f32_16x16x32_bf16 v[20:23], a[76:79], a[20:23], v[20:23]
    ds_read_b64_tr_b16 a[40:41], v246 offset:0
    v_mfma_f32_16x16x32_bf16 v[52:55], a[76:79], a[24:27], v[52:55]
    s_add_u32 m0, s54, 0
    ds_read_b64_tr_b16 a[42:43], v246 offset:3840
    v_mfma_f32_16x16x32_bf16 v[84:87], a[76:79], a[28:31], v[84:87]
    buffer_load_dwordx4 v4, s[20:23], s55 offen lds
    v_mfma_f32_16x16x32_bf16 v[116:119], a[76:79], a[32:35], v[116:119]
    ds_read_b128 a[0:3], v244 offset:2048
    v_mfma_f32_16x16x32_bf16 v[24:27], a[80:83], a[20:23], v[24:27]
    ds_read_b128 a[4:7], v244 offset:4096
    v_mfma_f32_16x16x32_bf16 v[56:59], a[80:83], a[24:27], v[56:59]
    s_add_u32 m0, s54, 4096
    ds_read_b128 a[8:11], v244 offset:6144
    v_mfma_f32_16x16x32_bf16 v[88:91], a[80:83], a[28:31], v[88:91]
    buffer_load_dwordx4 v5, s[20:23], s55 offen lds
    v_mfma_f32_16x16x32_bf16 v[120:123], a[80:83], a[32:35], v[120:123]
    ds_read_b128 a[12:15], v244 offset:8192
    v_mfma_f32_16x16x32_bf16 v[28:31], a[84:87], a[20:23], v[28:31]
    ds_read_b64_tr_b16 a[44:45], v246 offset:32
    v_mfma_f32_16x16x32_bf16 v[60:63], a[84:87], a[24:27], v[60:63]
    s_add_u32 m0, s54, 30720
    ds_read_b64_tr_b16 a[46:47], v246 offset:3872
    v_mfma_f32_16x16x32_bf16 v[92:95], a[84:87], a[28:31], v[92:95]
    buffer_load_dwordx4 v12, s[16:19], s56 offen lds
    v_mfma_f32_16x16x32_bf16 v[124:127], a[84:87], a[32:35], v[124:127]
    ds_read_b64_tr_b16 a[48:49], v246 offset:64
    v_mfma_f32_16x16x32_bf16 v[32:35], a[88:91], a[20:23], v[32:35]
    ds_read_b64_tr_b16 a[50:51], v246 offset:3904
    v_mfma_f32_16x16x32_bf16 v[64:67], a[88:91], a[24:27], v[64:67]
    s_add_u32 m0, s54, 8192
    ds_read_b64_tr_b16 a[52:53], v246 offset:96
    v_mfma_f32_16x16x32_bf16 v[96:99], a[88:91], a[28:31], v[96:99]
    buffer_load_dwordx4 v6, s[20:23], s55 offen lds
    v_mfma_f32_16x16x32_bf16 v[128:131], a[88:91], a[32:35], v[128:131]
    ds_read_b64_tr_b16 a[54:55], v246 offset:3936
    v_mfma_f32_16x16x32_bf16 v[36:39], a[92:95], a[20:23], v[36:39]
    s_add_u32 m0, s54, 34816
    ds_read_b64_tr_b16 a[56:57], v246 offset:128
    v_mfma_f32_16x16x32_bf16 v[68:71], a[92:95], a[24:27], v[68:71]
    buffer_load_dwordx4 v13, s[16:19], s56 offen lds
    v_mfma_f32_16x16x32_bf16 v[100:103], a[92:95], a[28:31], v[100:103]
    ds_read_b64_tr_b16 a[58:59], v246 offset:3968
    v_mfma_f32_16x16x32_bf16 v[132:135], a[92:95], a[32:35], v[132:135]
    ds_read_b128 a[16:19], v244
    v_mfma_f32_16x16x32_bf16 v[144:147], a[92:95], a[36:39], v[144:147]
    s_add_u32 m0, s54, 12288
    ds_read_b64_tr_b16 a[60:61], v246 offset:160
    v_mfma_f32_16x16x32_bf16 v[40:43], a[96:99], a[20:23], v[40:43]
    buffer_load_dwordx4 v7, s[20:23], s55 offen lds
    v_mfma_f32_16x16x32_bf16 v[72:75], a[96:99], a[24:27], v[72:75]
    ds_read_b64_tr_b16 a[62:63], v246 offset:4000
    v_mfma_f32_16x16x32_bf16 v[104:107], a[96:99], a[28:31], v[104:107]
    ds_read_b64_tr_b16 a[64:65], v246 offset:192
    v_mfma_f32_16x16x32_bf16 v[136:139], a[96:99], a[32:35], v[136:139]
    s_add_u32 m0, s54, 16384
    ds_read_b64_tr_b16 a[66:67], v246 offset:4032
    v_mfma_f32_16x16x32_bf16 v[44:47], a[100:103], a[20:23], v[44:47]
    buffer_load_dwordx4 v8, s[20:23], s55 offen lds
    v_mfma_f32_16x16x32_bf16 v[76:79], a[100:103], a[24:27], v[76:79]
    ds_read_b64_tr_b16 a[68:69], v246 offset:224
    v_mfma_f32_16x16x32_bf16 v[108:111], a[100:103], a[28:31], v[108:111]
    ds_read_b64_tr_b16 a[70:71], v246 offset:4064
    s_add_u32 s60, s60, 1
    v_mfma_f32_16x16x32_bf16 v[140:143], a[100:103], a[32:35], v[140:143]
    s_cmp_lt_u32 s60, 10
    s_cbranch_scc1 L_q_loop0
    s_waitcnt vmcnt(0) lgkmcnt(0)
    s_cmp_lg_u32 s50, 0
    s_cbranch_scc1 L_wp_pollq_skip
    s_waitcnt vmcnt(0)
    v_readfirstlane_b32 s61, v161
    s_nop 3
    s_cmp_ge_u32 s61, 128
    s_cbranch_scc1 L_wp_pollq_skip
    v_mov_b32 v2, 96
    s_mov_b32 s15, 400000
L_wp_pollq:
    global_load_dword v3, v2, s[48:49] sc1
    s_sub_u32 s15, s15, 1
    s_cbranch_scc1 L_wp_pollq_out
    s_waitcnt vmcnt(0)
    v_readfirstlane_b32 s61, v3
    s_nop 3
    s_cmp_ge_u32 s61, 128
    s_cbranch_scc1 L_wp_pollq_out
    s_sleep 1
    s_branch L_wp_pollq
L_wp_pollq_out:
L_wp_pollq_skip:
    s_barrier
    s_mul_i32 s61, s96, 5120
    s_mul_i32 s62, s50, 40960
    s_add_u32 s61, s61, s62
    v_lshlrev_b32 v240, 4, v1
    v_add_u32 v244, 0, v240
    v_add_u32 v240, s61, v240
    v_add_u32 v241, 4096, v240
    s_mul_i32 s61, s95, 303104
    s_lshl_b32 s62, s50, 10
    s_add_u32 s61, s61, s62
    v_add_u32 v244, s61, v244
    v_add_u32 v245, 75776, v244
    v_add_u32 v246, 151552, v244
    v_add_u32 v247, 227328, v244
    v_lshlrev_b32 v9, 3, v1
    v_add_u32 v8, 0, v9
    v_cvt_pk_bf16_f32 v248, v144, v145
    v_cvt_pk_bf16_f32 v249, v146, v147
    ds_write_b64 v9, v[248:249] offset:23040
    s_branch L_q_ex0
L_q_wave1:
    ds_read_b64_tr_b16 a[40:41], v246 offset:256
    ds_read_b64_tr_b16 a[42:43], v246 offset:4096
    ds_read_b128 a[0:3], v244 offset:2048
    ds_read_b128 a[4:7], v244 offset:4096
    ds_read_b128 a[8:11], v244 offset:6144
    ds_read_b128 a[12:15], v244 offset:8192
    ds_read_b128 a[16:19], v244
    ds_read_b64_tr_b16 a[44:45], v246 offset:288
    ds_read_b64_tr_b16 a[46:47], v246 offset:4128
    ds_read_b64_tr_b16 a[48:49], v246 offset:320
    ds_read_b64_tr_b16 a[50:51], v246 offset:4160
    ds_read_b64_tr_b16 a[52:53], v246 offset:352
    ds_read_b64_tr_b16 a[54:55], v246 offset:4192
    ds_read_b64_tr_b16 a[56:57], v246 offset:384
    ds_read_b64_tr_b16 a[58:59], v246 offset:4224
    ds_read_b64_tr_b16 a[60:61], v246 offset:416
    ds_read_b64_tr_b16 a[62:63], v246 offset:4256
    ds_read_b64_tr_b16 a[64:65], v246 offset:448
    ds_read_b64_tr_b16 a[66:67], v246 offset:4288
    s_waitcnt lgkmcnt(13)
    v_mfma_f32_16x16x32_bf16 v[16:19], a[40:43], a[0:3], 0
    s_add_u32 m0, s54, 0
    ds_read_b64_tr_b16 a[72:73], v246 offset:15616
    v_mfma_f32_16x16x32_bf16 v[48:51], a[40:43], a[4:7], 0
    buffer_load_dwordx4 v4, s[20:23], s55 offen lds
    v_mfma_f32_16x16x32_bf16 v[80:83], a[40:43], a[8:11], 0
    s_add_u32 m0, s54, 4096
    ds_read_b64_tr_b16 a[74:75], v246 offset:19456
    v_mfma_f32_16x16x32_bf16 v[112:115], a[40:43], a[12:15], 0
    buffer_load_dwordx4 v5, s[20:23], s55 offen lds
    s_waitcnt lgkmcnt(12)
    v_mfma_f32_16x16x32_bf16 v[144:147], a[40:43], a[16:19], 0
    s_add_u32 m0, s54, 30720
    ds_read_b128 a[20:23], v245 offset:2048
    v_mfma_f32_16x16x32_bf16 v[20:23], a[44:47], a[0:3], 0
    buffer_load_dwordx4 v12, s[16:19], s56 offen lds
    v_mfma_f32_16x16x32_bf16 v[52:55], a[44:47], a[4:7], 0
    s_add_u32 m0, s54, 8192
    ds_read_b128 a[24:27], v245 offset:4096
    v_mfma_f32_16x16x32_bf16 v[84:87], a[44:47], a[8:11], 0
    buffer_load_dwordx4 v6, s[20:23], s55 offen lds
    v_mfma_f32_16x16x32_bf16 v[116:119], a[44:47], a[12:15], 0
    s_add_u32 m0, s54, 34816
    ds_read_b128 a[28:31], v245 offset:6144
    v_mfma_f32_16x16x32_bf16 v[148:151], a[44:47], a[16:19], 0
    buffer_load_dwordx4 v13, s[16:19], s56 offen lds
    s_add_u32 m0, s54, 12288
    s_waitcnt lgkmcnt(13)
    v_mfma_f32_16x16x32_bf16 v[24:27], a[0:3], a[48:51], 0
    buffer_load_dwordx4 v7, s[20:23], s55 offen lds
    v_mfma_f32_16x16x32_bf16 v[56:59], a[4:7], a[48:51], 0
    s_add_u32 m0, s54, 16384
    ds_read_b128 a[32:35], v245 offset:8192
    v_mfma_f32_16x16x32_bf16 v[88:91], a[8:11], a[48:51], 0
    buffer_load_dwordx4 v8, s[20:23], s55 offen lds
    v_mfma_f32_16x16x32_bf16 v[120:123], a[12:15], a[48:51], 0
    ds_read_b128 a[36:39], v245
    v_mfma_f32_16x16x32_bf16 v[152:155], a[16:19], a[48:51], 0
    buffer_load_dwordx4 v[208:211], v212, s[20:23], 0 offen
    s_waitcnt lgkmcnt(13)
    v_mfma_f32_16x16x32_bf16 v[28:31], a[0:3], a[52:55], 0
    v_add_u32 v212, 4096, v212
    ds_read_b64_tr_b16 a[76:77], v246 offset:15648
    v_mfma_f32_16x16x32_bf16 v[60:63], a[4:7], a[52:55], 0
    buffer_load_dwordx4 v[208:211], v212, s[20:23], 0 offen
    v_mfma_f32_16x16x32_bf16 v[92:95], a[8:11], a[52:55], 0
    v_add_u32 v212, 4096, v212
    ds_read_b64_tr_b16 a[78:79], v246 offset:19488
    v_mfma_f32_16x16x32_bf16 v[124:127], a[12:15], a[52:55], 0
    buffer_load_dwordx4 v[208:211], v212, s[20:23], 0 offen
    v_mfma_f32_16x16x32_bf16 v[156:159], a[16:19], a[52:55], 0
    v_add_u32 v212, 4096, v212
    ds_read_b64_tr_b16 a[80:81], v246 offset:15680
    s_waitcnt lgkmcnt(14)
    v_mfma_f32_16x16x32_bf16 v[32:35], a[0:3], a[56:59], 0
    buffer_load_dwordx4 v[208:211], v212, s[20:23], 0 offen
    s_add_u32 m0, s54, 20480
    v_mfma_f32_16x16x32_bf16 v[64:67], a[4:7], a[56:59], 0
    buffer_load_dwordx4 v9, s[20:23], s55 offen lds
    v_mfma_f32_16x16x32_bf16 v[96:99], a[8:11], a[56:59], 0
    s_add_u32 m0, s54, 38912
    ds_read_b64_tr_b16 a[82:83], v246 offset:19520
    v_mfma_f32_16x16x32_bf16 v[128:131], a[12:15], a[56:59], 0
    buffer_load_dwordx4 v14, s[16:19], s56 offen lds
    s_waitcnt lgkmcnt(13)
    v_mfma_f32_16x16x32_bf16 v[36:39], a[0:3], a[60:63], 0
    s_add_u32 m0, s54, 24576
    ds_read_b64_tr_b16 a[84:85], v246 offset:15712
    v_mfma_f32_16x16x32_bf16 v[68:71], a[4:7], a[60:63], 0
    buffer_load_dwordx4 v10, s[20:23], s55 offen lds
    v_mfma_f32_16x16x32_bf16 v[100:103], a[8:11], a[60:63], 0
    s_add_u32 m0, s54, s58
    ds_read_b64_tr_b16 a[86:87], v246 offset:19552
    v_mfma_f32_16x16x32_bf16 v[132:135], a[12:15], a[60:63], 0
    buffer_load_dwordx4 v11, s[24:27], s57 offen lds
    s_waitcnt lgkmcnt(13)
    v_mfma_f32_16x16x32_bf16 v[40:43], a[0:3], a[64:67], 0
    s_add_u32 m0, s54, 43008
    ds_read_b64_tr_b16 a[88:89], v246 offset:15744
    v_mfma_f32_16x16x32_bf16 v[72:75], a[4:7], a[64:67], 0
    buffer_load_dwordx4 v15, s[16:19], s56 offen lds
    v_mfma_f32_16x16x32_bf16 v[104:107], a[8:11], a[64:67], 0
    ds_read_b64_tr_b16 a[90:91], v246 offset:19584
    v_mfma_f32_16x16x32_bf16 v[136:139], a[12:15], a[64:67], 0
    ds_read_b64_tr_b16 a[92:93], v246 offset:15776
    ds_read_b64_tr_b16 a[94:95], v246 offset:19616
    ds_read_b64_tr_b16 a[96:97], v246 offset:15808
    ds_read_b64_tr_b16 a[98:99], v246 offset:19648
    s_add_u32 s54, s53, s67
    s_add_u32 s61, s60, 3
    s_xor_b32 s61, s61, s14
    s_mul_i32 s55, s61, 245760
    s_lshl_b32 s56, s61, 7
    s_mul_i32 s57, s61, s59
    s_cmp_lt_u32 s60, 7
    s_cselect_b32 s22, s65, 0
    s_cselect_b32 s18, s64, 0
    s_cselect_b32 s26, s66, 0
    s_add_u32 s53, s53, 49152
    s_cmp_eq_u32 s53, 147456
    s_cselect_b32 s53, 0, s53
    v_add_u32 v244, s53, v240
    v_add_u32 v246, s53, v242
    v_add_u32 v245, s53, v241
    s_waitcnt lgkmcnt(15)
    s_branch L_q_loop1_B
L_q_loop1:
    s_waitcnt lgkmcnt(13)
    v_mfma_f32_16x16x32_bf16 v[16:19], a[40:43], a[0:3], v[16:19]
    ds_read_b64_tr_b16 a[72:73], v246 offset:15616
    v_mfma_f32_16x16x32_bf16 v[48:51], a[40:43], a[4:7], v[48:51]
    ds_read_b64_tr_b16 a[74:75], v246 offset:19456
    v_mfma_f32_16x16x32_bf16 v[80:83], a[40:43], a[8:11], v[80:83]
    s_add_u32 m0, s54, 20480
    ds_read_b128 a[20:23], v245 offset:2048
    v_mfma_f32_16x16x32_bf16 v[112:115], a[40:43], a[12:15], v[112:115]
    buffer_load_dwordx4 v9, s[20:23], s55 offen lds
    s_waitcnt lgkmcnt(13)
    v_mfma_f32_16x16x32_bf16 v[144:147], a[40:43], a[16:19], v[144:147]
    ds_read_b128 a[24:27], v245 offset:4096
    v_mfma_f32_16x16x32_bf16 v[20:23], a[44:47], a[0:3], v[20:23]
    ds_read_b128 a[28:31], v245 offset:6144
    v_mfma_f32_16x16x32_bf16 v[52:55], a[44:47], a[4:7], v[52:55]
    s_add_u32 m0, s54, 38912
    ds_read_b128 a[32:35], v245 offset:8192
    v_mfma_f32_16x16x32_bf16 v[84:87], a[44:47], a[8:11], v[84:87]
    buffer_load_dwordx4 v14, s[16:19], s56 offen lds
    v_mfma_f32_16x16x32_bf16 v[116:119], a[44:47], a[12:15], v[116:119]
    ds_read_b128 a[36:39], v245
    v_mfma_f32_16x16x32_bf16 v[148:151], a[44:47], a[16:19], v[148:151]
    ds_read_b64_tr_b16 a[76:77], v246 offset:15648
    s_waitcnt lgkmcnt(15)
    v_mfma_f32_16x16x32_bf16 v[24:27], a[0:3], a[48:51], v[24:27]
    s_add_u32 m0, s54, 24576
    ds_read_b64_tr_b16 a[78:79], v246 offset:19488
    v_mfma_f32_16x16x32_bf16 v[56:59], a[4:7], a[48:51], v[56:59]
    buffer_load_dwordx4 v10, s[20:23], s55 offen lds
    v_mfma_f32_16x16x32_bf16 v[88:91], a[8:11], a[48:51], v[88:91]
    ds_read_b64_tr_b16 a[80:81], v246 offset:15680
    v_mfma_f32_16x16x32_bf16 v[120:123], a[12:15], a[48:51], v[120:123]
    ds_read_b64_tr_b16 a[82:83], v246 offset:19520
    v_mfma_f32_16x16x32_bf16 v[152:155], a[16:19], a[48:51], v[152:155]
    s_add_u32 m0, s54, s58
    ds_read_b64_tr_b16 a[84:85], v246 offset:15712
    s_waitcnt lgkmcnt(15)
    v_mfma_f32_16x16x32_bf16 v[28:31], a[0:3], a[52:55], v[28:31]
    buffer_load_dwordx4 v11, s[24:27], s57 offen lds
    v_mfma_f32_16x16x32_bf16 v[60:63], a[4:7], a[52:55], v[60:63]
    ds_read_b64_tr_b16 a[86:87], v246 offset:19552
    v_mfma_f32_16x16x32_bf16 v[92:95], a[8:11], a[52:55], v[92:95]
    ds_read_b64_tr_b16 a[88:89], v246 offset:15744
    v_mfma_f32_16x16x32_bf16 v[124:127], a[12:15], a[52:55], v[124:127]
    s_add_u32 m0, s54, 43008
    ds_read_b64_tr_b16 a[90:91], v246 offset:19584
    v_mfma_f32_16x16x32_bf16 v[156:159], a[16:19], a[52:55], v[156:159]
    buffer_load_dwordx4 v15, s[16:19], s56 offen lds
    v_mfma_f32_16x16x32_bf16 v[32:35], a[0:3], a[56:59], v[32:35]
    ds_read_b64_tr_b16 a[92:93], v246 offset:15776
    v_mfma_f32_16x16x32_bf16 v[64:67], a[4:7], a[56:59], v[64:67]
    ds_read_b64_tr_b16 a[94:95], v246 offset:19616
    v_mfma_f32_16x16x32_bf16 v[96:99], a[8:11], a[56:59], v[96:99]
    ds_read_b64_tr_b16 a[96:97], v246 offset:15808
    v_mfma_f32_16x16x32_bf16 v[128:131], a[12:15], a[56:59], v[128:131]
    ds_read_b64_tr_b16 a[98:99], v246 offset:19648
    s_add_u32 s54, s53, s67
    s_waitcnt lgkmcnt(15)
    v_mfma_f32_16x16x32_bf16 v[36:39], a[0:3], a[60:63], v[36:39]
    s_add_u32 s61, s60, 3
    s_xor_b32 s61, s61, s14
    s_mul_i32 s55, s61, 245760
    v_mfma_f32_16x16x32_bf16 v[68:71], a[4:7], a[60:63], v[68:71]
    s_lshl_b32 s56, s61, 7
    s_mul_i32 s57, s61, s59
    s_cmp_lt_u32 s60, 7
    v_mfma_f32_16x16x32_bf16 v[100:103], a[8:11], a[60:63], v[100:103]
    s_cselect_b32 s22, s65, 0
    s_cselect_b32 s18, s64, 0
    s_cselect_b32 s26, s66, 0
    v_mfma_f32_16x16x32_bf16 v[132:135], a[12:15], a[60:63], v[132:135]
    s_add_u32 s53, s53, 49152
    s_cmp_eq_u32 s53, 147456
    s_cselect_b32 s53, 0, s53
    v_mfma_f32_16x16x32_bf16 v[40:43], a[0:3], a[64:67], v[40:43]
    v_add_u32 v244, s53, v240
    v_mfma_f32_16x16x32_bf16 v[72:75], a[4:7], a[64:67], v[72:75]
    v_add_u32 v246, s53, v242
    v_mfma_f32_16x16x32_bf16 v[104:107], a[8:11], a[64:67], v[104:107]
    v_add_u32 v245, s53, v241
    v_mfma_f32_16x16x32_bf16 v[136:139], a[12:15], a[64:67], v[136:139]
L_q_loop1_B:
    v_mfma_f32_16x16x32_bf16 v[16:19], a[72:75], a[20:23], v[16:19]
    v_mfma_f32_16x16x32_bf16 v[48:51], a[72:75], a[24:27], v[48:51]
    s_waitcnt lgkmcnt(10)
    v_mfma_f32_16x16x32_bf16 v[80:83], a[72:75], a[28:31], v[80:83]
    v_mfma_f32_16x16x32_bf16 v[112:115], a[72:75], a[32:35], v[112:115]
    s_cmp_eq_u32 s60, 0
    s_cbranch_scc1 L_q_alt1
    s_waitcnt vmcnt(12) lgkmcnt(0)
L_q_alt_ret1:
    s_barrier
    v_mfma_f32_16x16x32_bf16 v[144:147], a[72:75], a[36:39], v[144:147]
    ds_read_b64_tr_b16 a[40:41], v246 offset:256
    v_mfma_f32_16x16x32_bf16 v[20:23], a[76:79], a[20:23], v[20:23]
    s_add_u32 m0, s54, 0
    ds_read_b64_tr_b16 a[42:43], v246 offset:4096
    v_mfma_f32_16x16x32_bf16 v[52:55], a[76:79], a[24:27], v[52:55]
    buffer_load_dwordx4 v4, s[20:23], s55 offen lds
    v_mfma_f32_16x16x32_bf16 v[84:87], a[76:79], a[28:31], v[84:87]
    ds_read_b128 a[0:3], v244 offset:2048
    v_mfma_f32_16x16x32_bf16 v[116:119], a[76:79], a[32:35], v[116:119]
    ds_read_b128 a[4:7], v244 offset:4096
    v_mfma_f32_16x16x32_bf16 v[148:151], a[76:79], a[36:39], v[148:151]
    s_add_u32 m0, s54, 4096
    ds_read_b128 a[8:11], v244 offset:6144
    v_mfma_f32_16x16x32_bf16 v[24:27], a[20:23], a[80:83], v[24:27]
    buffer_load_dwordx4 v5, s[20:23], s55 offen lds
    v_mfma_f32_16x16x32_bf16 v[56:59], a[24:27], a[80:83], v[56:59]
    ds_read_b128 a[12:15], v244 offset:8192
    v_mfma_f32_16x16x32_bf16 v[88:91], a[28:31], a[80:83], v[88:91]
    s_add_u32 m0, s54, 30720
    ds_read_b128 a[16:19], v244
    v_mfma_f32_16x16x32_bf16 v[120:123], a[32:35], a[80:83], v[120:123]
    buffer_load_dwordx4 v12, s[16:19], s56 offen lds
    v_mfma_f32_16x16x32_bf16 v[152:155], a[36:39], a[80:83], v[152:155]
    ds_read_b64_tr_b16 a[44:45], v246 offset:288
    v_mfma_f32_16x16x32_bf16 v[28:31], a[20:23], a[84:87], v[28:31]
    ds_read_b64_tr_b16 a[46:47], v246 offset:4128
    v_mfma_f32_16x16x32_bf16 v[60:63], a[24:27], a[84:87], v[60:63]
    s_add_u32 m0, s54, 8192
    ds_read_b64_tr_b16 a[48:49], v246 offset:320
    v_mfma_f32_16x16x32_bf16 v[92:95], a[28:31], a[84:87], v[92:95]
    buffer_load_dwordx4 v6, s[20:23], s55 offen lds
    v_mfma_f32_16x16x32_bf16 v[124:127], a[32:35], a[84:87], v[124:127]
    ds_read_b64_tr_b16 a[50:51], v246 offset:4160
    v_mfma_f32_16x16x32_bf16 v[156:159], a[36:39], a[84:87], v[156:159]
    ds_read_b64_tr_b16 a[52:53], v246 offset:352
    v_mfma_f32_16x16x32_bf16 v[32:35], a[20:23], a[88:91], v[32:35]
    s_add_u32 m0, s54, 34816
    ds_read_b64_tr_b16 a[54:55], v246 offset:4192
    v_mfma_f32_16x16x32_bf16 v[64:67], a[24:27], a[88:91], v[64:67]
    buffer_load_dwordx4 v13, s[16:19], s56 offen lds
    v_mfma_f32_16x16x32_bf16 v[96:99], a[28:31], a[88:91], v[96:99]
    ds_read_b64_tr_b16 a[56:57], v246 offset:384
    v_mfma_f32_16x16x32_bf16 v[128:131], a[32:35], a[88:91], v[128:131]
    s_add_u32 m0, s54, 12288
    ds_read_b64_tr_b16 a[58:59], v246 offset:4224
    v_mfma_f32_16x16x32_bf16 v[36:39], a[20:23], a[92:95], v[36:39]
    buffer_load_dwordx4 v7, s[20:23], s55 offen lds
    v_mfma_f32_16x16x32_bf16 v[68:71], a[24:27], a[92:95], v[68:71]
    ds_read_b64_tr_b16 a[60:61], v246 offset:416
    v_mfma_f32_16x16x32_bf16 v[100:103], a[28:31], a[92:95], v[100:103]
    ds_read_b64_tr_b16 a[62:63], v246 offset:4256
    v_mfma_f32_16x16x32_bf16 v[132:135], a[32:35], a[92:95], v[132:135]
    s_add_u32 m0, s54, 16384
    ds_read_b64_tr_b16 a[64:65], v246 offset:448
    v_mfma_f32_16x16x32_bf16 v[40:43], a[20:23], a[96:99], v[40:43]
    buffer_load_dwordx4 v8, s[20:23], s55 offen lds
    v_mfma_f32_16x16x32_bf16 v[72:75], a[24:27], a[96:99], v[72:75]
    ds_read_b64_tr_b16 a[66:67], v246 offset:4288
    s_add_u32 s60, s60, 1
    v_mfma_f32_16x16x32_bf16 v[104:107], a[28:31], a[96:99], v[104:107]
    s_cmp_lt_u32 s60, 10
    v_mfma_f32_16x16x32_bf16 v[136:139], a[32:35], a[96:99], v[136:139]
    s_cbranch_scc1 L_q_loop1
    s_waitcnt vmcnt(0) lgkmcnt(0)
    s_barrier
    s_mul_i32 s61, s96, 5120
    s_mul_i32 s62, s50, 40960
    s_add_u32 s61, s61, s62
    v_lshlrev_b32 v240, 4, v1
    v_add_u32 v244, 0, v240
    v_add_u32 v240, s61, v240
    v_add_u32 v241, 4096, v240
    s_mul_i32 s61, s95, 303104
    s_lshl_b32 s62, s50, 10
    s_add_u32 s61, s61, s62
    v_add_u32 v244, s61, v244
    v_add_u32 v245, 75776, v244
    v_add_u32 v246, 151552, v244
    v_add_u32 v247, 227328, v244
    v_lshlrev_b32 v9, 3, v1
    v_add_u32 v8, 0, v9
    v_cvt_pk_bf16_f32 v248, v144, v145
    v_cvt_pk_bf16_f32 v249, v146, v147
    ds_write_b64 v9, v[248:249] offset:24576
    v_cvt_pk_bf16_f32 v250, v148, v149
    v_cvt_pk_bf16_f32 v251, v150, v151
    ds_write_b64 v9, v[250:251] offset:25088
    v_cvt_pk_bf16_f32 v252, v152, v153
    v_cvt_pk_bf16_f32 v253, v154, v155
    ds_write_b64 v9, v[252:253] offset:46080
    v_cvt_pk_bf16_f32 v254, v156, v157
    v_cvt_pk_bf16_f32 v255, v158, v159
    ds_write_b64 v9, v[254:255] offset:46592
    s_branch L_q_ex1
L_q_wave2:
    ds_read_b64_tr_b16 a[40:41], v246 offset:0
    ds_read_b64_tr_b16 a[42:43], v246 offset:3840
    ds_read_b128 a[0:3], v244 offset:10240
    ds_read_b128 a[4:7], v244 offset:12288
    ds_read_b128 a[8:11], v244 offset:14336
    ds_read_b128 a[12:15], v244 offset:16384
    ds_read_b64_tr_b16 a[44:45], v246 offset:32
    ds_read_b64_tr_b16 a[46:47], v246 offset:3872
    ds_read_b64_tr_b16 a[48:49], v246 offset:64
    ds_read_b64_tr_b16 a[50:51], v246 offset:3904
    ds_read_b64_tr_b16 a[52:53], v246 offset:96
    ds_read_b64_tr_b16 a[54:55], v246 offset:3936
    ds_read_b64_tr_b16 a[56:57], v246 offset:128
    ds_read_b64_tr_b16 a[58:59], v246 offset:3968
    ds_read_b64_tr_b16 a[60:61], v246 offset:160
    ds_read_b64_tr_b16 a[62:63], v246 offset:4000
    ds_read_b128 a[16:19], v244
    ds_read_b64_tr_b16 a[64:65], v246 offset:192
    ds_read_b64_tr_b16 a[66:67], v246 offset:4032
    ds_read_b64_tr_b16 a[68:69], v246 offset:224
    ds_read_b64_tr_b16 a[70:71], v246 offset:4064
    s_waitcnt lgkmcnt(15)
    v_mfma_f32_16x16x32_bf16 v[16:19], a[40:43], a[0:3], 0
    s_add_u32 m0, s54, 0
    ds_read_b64_tr_b16 a[72:73], v246 offset:15360
    v_mfma_f32_16x16x32_bf16 v[48:51], a[40:43], a[4:7], 0
    buffer_load_dwordx4 v4, s[20:23], s55 offen lds
    v_mfma_f32_16x16x32_bf16 v[80:83], a[40:43], a[8:11], 0
    s_add_u32 m0, s54, 4096
    ds_read_b64_tr_b16 a[74:75], v246 offset:19200
    v_mfma_f32_16x16x32_bf16 v[112:115], a[40:43], a[12:15], 0
    buffer_load_dwordx4 v5, s[20:23], s55 offen lds
    s_waitcnt lgkmcnt(15)
    v_mfma_f32_16x16x32_bf16 v[20:23], a[44:47], a[0:3], 0
    s_add_u32 m0, s54, 30720
    ds_read_b128 a[20:23], v245 offset:10240
    v_mfma_f32_16x16x32_bf16 v[52:55], a[44:47], a[4:7], 0
    buffer_load_dwordx4 v12, s[16:19], s56 offen lds
    v_mfma_f32_16x16x32_bf16 v[84:87], a[44:47], a[8:11], 0
    s_add_u32 m0, s54, 8192
    ds_read_b128 a[24:27], v245 offset:12288
    v_mfma_f32_16x16x32_bf16 v[116:119], a[44:47], a[12:15], 0
    buffer_load_dwordx4 v6, s[20:23], s55 offen lds
    s_waitcnt lgkmcnt(15)
    v_mfma_f32_16x16x32_bf16 v[24:27], a[48:51], a[0:3], 0
    s_add_u32 m0, s54, 34816
    ds_read_b128 a[28:31], v245 offset:14336
    v_mfma_f32_16x16x32_bf16 v[56:59], a[48:51], a[4:7], 0
    buffer_load_dwordx4 v13, s[16:19], s56 offen lds
    v_mfma_f32_16x16x32_bf16 v[88:91], a[48:51], a[8:11], 0
    s_add_u32 m0, s54, 12288
    ds_read_b128 a[32:35], v245 offset:16384
    v_mfma_f32_16x16x32_bf16 v[120:123], a[48:51], a[12:15], 0
    buffer_load_dwordx4 v7, s[20:23], s55 offen lds
    s_waitcnt lgkmcnt(15)
    v_mfma_f32_16x16x32_bf16 v[28:31], a[52:55], a[0:3], 0
    s_add_u32 m0, s54, 16384
    ds_read_b64_tr_b16 a[76:77], v246 offset:15392
    v_mfma_f32_16x16x32_bf16 v[60:63], a[52:55], a[4:7], 0
    buffer_load_dwordx4 v8, s[20:23], s55 offen lds
    v_mfma_f32_16x16x32_bf16 v[92:95], a[52:55], a[8:11], 0
    ds_read_b64_tr_b16 a[78:79], v246 offset:19232
    v_mfma_f32_16x16x32_bf16 v[124:127], a[52:55], a[12:15], 0
    buffer_load_dwordx4 v[208:211], v212, s[20:23], 0 offen
    v_add_u32 v212, 4096, v212
    s_waitcnt lgkmcnt(15)
    v_mfma_f32_16x16x32_bf16 v[32:35], a[56:59], a[0:3], 0
    buffer_load_dwordx4 v[208:211], v212, s[20:23], 0 offen
    v_mfma_f32_16x16x32_bf16 v[64:67], a[56:59], a[4:7], 0
    v_add_u32 v212, 4096, v212
    ds_read_b64_tr_b16 a[80:81], v246 offset:15424
    v_mfma_f32_16x16x32_bf16 v[96:99], a[56:59], a[8:11], 0
    buffer_load_dwordx4 v[208:211], v212, s[20:23], 0 offen
    v_mfma_f32_16x16x32_bf16 v[128:131], a[56:59], a[12:15], 0
    v_add_u32 v212, 4096, v212
    ds_read_b64_tr_b16 a[82:83], v246 offset:19264
    s_waitcnt lgkmcnt(15)
    v_mfma_f32_16x16x32_bf16 v[36:39], a[60:63], a[0:3], 0
    buffer_load_dwordx4 v[208:211], v212, s[20:23], 0 offen
    v_mfma_f32_16x16x32_bf16 v[68:71], a[60:63], a[4:7], 0
    s_add_u32 m0, s54, 20480
    ds_read_b64_tr_b16 a[84:85], v246 offset:15456
    v_mfma_f32_16x16x32_bf16 v[100:103], a[60:63], a[8:11], 0
    buffer_load_dwordx4 v9, s[20:23], s55 offen lds
    v_mfma_f32_16x16x32_bf16 v[132:135], a[60:63], a[12:15], 0
    s_add_u32 m0, s54, 38912
    ds_read_b64_tr_b16 a[86:87], v246 offset:19296
    s_waitcnt lgkmcnt(14)
    v_mfma_f32_16x16x32_bf16 v[40:43], a[64:67], a[0:3], 0
    buffer_load_dwordx4 v14, s[16:19], s56 offen lds
    v_mfma_f32_16x16x32_bf16 v[72:75], a[64:67], a[4:7], 0
    s_add_u32 m0, s54, 24576
    ds_read_b64_tr_b16 a[88:89], v246 offset:15488
    v_mfma_f32_16x16x32_bf16 v[104:107], a[64:67], a[8:11], 0
    buffer_load_dwordx4 v10, s[20:23], s55 offen lds
    v_mfma_f32_16x16x32_bf16 v[136:139], a[64:67], a[12:15], 0
    s_add_u32 m0, s54, s58
    ds_read_b64_tr_b16 a[90:91], v246 offset:19328
    v_mfma_f32_16x16x32_bf16 v[144:147], a[64:67], a[16:19], 0
    buffer_load_dwordx4 v11, s[24:27], s57 offen lds
    s_waitcnt lgkmcnt(14)
    v_mfma_f32_16x16x32_bf16 v[44:47], a[68:71], a[0:3], 0
    s_add_u32 m0, s54, 43008
    ds_read_b64_tr_b16 a[92:93], v246 offset:15520
    v_mfma_f32_16x16x32_bf16 v[76:79], a[68:71], a[4:7], 0
    buffer_load_dwordx4 v15, s[16:19], s56 offen lds
    v_mfma_f32_16x16x32_bf16 v[108:111], a[68:71], a[8:11], 0
    ds_read_b64_tr_b16 a[94:95], v246 offset:19360
    v_mfma_f32_16x16x32_bf16 v[140:143], a[68:71], a[12:15], 0
    ds_read_b128 a[36:39], v245
    ds_read_b64_tr_b16 a[96:97], v246 offset:15552
    ds_read_b64_tr_b16 a[98:99], v246 offset:19392
    ds_read_b64_tr_b16 a[100:101], v246 offset:15584
    ds_read_b64_tr_b16 a[102:103], v246 offset:19424
    s_add_u32 s54, s53, s67
    s_add_u32 s61, s60, 3
    s_xor_b32 s61, s61, s14
    s_mul_i32 s55, s61, 245760
    s_lshl_b32 s56, s61, 7
    s_mul_i32 s57, s61, s59
    s_cmp_lt_u32 s60, 7
    s_cselect_b32 s22, s65, 0
    s_cselect_b32 s18, s64, 0
    s_cselect_b32 s26, s66, 0
    s_add_u32 s53, s53, 49152
    s_cmp_eq_u32 s53, 147456
    s_cselect_b32 s53, 0, s53
    v_add_u32 v244, s53, v240
    v_add_u32 v246, s53, v242
    v_add_u32 v245, s53, v241
    s_waitcnt lgkmcnt(15)
    s_branch L_q_loop2_B
L_q_loop2:
    s_waitcnt lgkmcnt(15)
    v_mfma_f32_16x16x32_bf16 v[16:19], a[40:43], a[0:3], v[16:19]
    ds_read_b64_tr_b16 a[72:73], v246 offset:15360
    v_mfma_f32_16x16x32_bf16 v[48:51], a[40:43], a[4:7], v[48:51]
    ds_read_b64_tr_b16 a[74:75], v246 offset:19200
    v_mfma_f32_16x16x32_bf16 v[80:83], a[40:43], a[8:11], v[80:83]
    s_add_u32 m0, s54, 20480
    ds_read_b128 a[20:23], v245 offset:10240
    v_mfma_f32_16x16x32_bf16 v[112:115], a[40:43], a[12:15], v[112:115]
    buffer_load_dwordx4 v9, s[20:23], s55 offen lds
    s_waitcnt lgkmcnt(15)
    v_mfma_f32_16x16x32_bf16 v[20:23], a[44:47], a[0:3], v[20:23]
    ds_read_b128 a[24:27], v245 offset:12288
    v_mfma_f32_16x16x32_bf16 v[52:55], a[44:47], a[4:7], v[52:55]
    ds_read_b128 a[28:31], v245 offset:14336
    v_mfma_f32_16x16x32_bf16 v[84:87], a[44:47], a[8:11], v[84:87]
    s_add_u32 m0, s54, 38912
    ds_read_b128 a[32:35], v245 offset:16384
    v_mfma_f32_16x16x32_bf16 v[116:119], a[44:47], a[12:15], v[116:119]
    buffer_load_dwordx4 v14, s[16:19], s56 offen lds
    s_waitcnt lgkmcnt(15)
    v_mfma_f32_16x16x32_bf16 v[24:27], a[48:51], a[0:3], v[24:27]
    ds_read_b64_tr_b16 a[76:77], v246 offset:15392
    v_mfma_f32_16x16x32_bf16 v[56:59], a[48:51], a[4:7], v[56:59]
    ds_read_b64_tr_b16 a[78:79], v246 offset:19232
    v_mfma_f32_16x16x32_bf16 v[88:91], a[48:51], a[8:11], v[88:91]
    s_add_u32 m0, s54, 24576
    ds_read_b64_tr_b16 a[80:81], v246 offset:15424
    v_mfma_f32_16x16x32_bf16 v[120:123], a[48:51], a[12:15], v[120:123]
    buffer_load_dwordx4 v10, s[20:23], s55 offen lds
    v_mfma_f32_16x16x32_bf16 v[28:31], a[52:55], a[0:3], v[28:31]
    ds_read_b64_tr_b16 a[82:83], v246 offset:19264
    v_mfma_f32_16x16x32_bf16 v[60:63], a[52:55], a[4:7], v[60:63]
    ds_read_b64_tr_b16 a[84:85], v246 offset:15456
    v_mfma_f32_16x16x32_bf16 v[92:95], a[52:55], a[8:11], v[92:95]
    s_add_u32 m0, s54, s58
    ds_read_b64_tr_b16 a[86:87], v246 offset:19296
    v_mfma_f32_16x16x32_bf16 v[124:127], a[52:55], a[12:15], v[124:127]
    buffer_load_dwordx4 v11, s[24:27], s57 offen lds
    s_waitcnt lgkmcnt(15)
    v_mfma_f32_16x16x32_bf16 v[32:35], a[56:59], a[0:3], v[32:35]
    ds_read_b64_tr_b16 a[88:89], v246 offset:15488
    v_mfma_f32_16x16x32_bf16 v[64:67], a[56:59], a[4:7], v[64:67]
    ds_read_b64_tr_b16 a[90:91], v246 offset:19328
    v_mfma_f32_16x16x32_bf16 v[96:99], a[56:59], a[8:11], v[96:99]
    s_add_u32 m0, s54, 43008
    ds_read_b64_tr_b16 a[92:93], v246 offset:15520
    v_mfma_f32_16x16x32_bf16 v[128:131], a[56:59], a[12:15], v[128:131]
    buffer_load_dwordx4 v15, s[16:19], s56 offen lds
    v_mfma_f32_16x16x32_bf16 v[36:39], a[60:63], a[0:3], v[36:39]
    ds_read_b64_tr_b16 a[94:95], v246 offset:19360
    v_mfma_f32_16x16x32_bf16 v[68:71], a[60:63], a[4:7], v[68:71]
    ds_read_b128 a[36:39], v245
    v_mfma_f32_16x16x32_bf16 v[100:103], a[60:63], a[8:11], v[100:103]
    ds_read_b64_tr_b16 a[96:97], v246 offset:15552
    v_mfma_f32_16x16x32_bf16 v[132:135], a[60:63], a[12:15], v[132:135]
    ds_read_b64_tr_b16 a[98:99], v246 offset:19392
    s_waitcnt lgkmcnt(15)
    v_mfma_f32_16x16x32_bf16 v[40:43], a[64:67], a[0:3], v[40:43]
    ds_read_b64_tr_b16 a[100:101], v246 offset:15584
    v_mfma_f32_16x16x32_bf16 v[72:75], a[64:67], a[4:7], v[72:75]
    ds_read_b64_tr_b16 a[102:103], v246 offset:19424
    s_add_u32 s54, s53, s67
    v_mfma_f32_16x16x32_bf16 v[104:107], a[64:67], a[8:11], v[104:107]
    s_add_u32 s61, s60, 3
    s_xor_b32 s61, s61, s14
    s_mul_i32 s55, s61, 245760
    v_mfma_f32_16x16x32_bf16 v[136:139], a[64:67], a[12:15], v[136:139]
    s_lshl_b32 s56, s61, 7
    s_mul_i32 s57, s61, s59
    s_cmp_lt_u32 s60, 7
    v_mfma_f32_16x16x32_bf16 v[144:147], a[64:67], a[16:19], v[144:147]
    s_cselect_b32 s22, s65, 0
    s_cselect_b32 s18, s64, 0
    s_cselect_b32 s26, s66, 0
    v_mfma_f32_16x16x32_bf16 v[44:47], a[68:71], a[0:3], v[44:47]
    s_add_u32 s53, s53, 49152
    s_cmp_eq_u32 s53, 147456
    s_cselect_b32 s53, 0, s53
    v_mfma_f32_16x16x32_bf16 v[76:79], a[68:71], a[4:7], v[76:79]
    v_add_u32 v244, s53, v240
    v_mfma_f32_16x16x32_bf16 v[108:111], a[68:71], a[8:11], v[108:111]
    v_add_u32 v246, s53, v242
    v_mfma_f32_16x16x32_bf16 v[140:143], a[68:71], a[12:15], v[140:143]
    v_add_u32 v245, s53, v241
L_q_loop2_B:
    v_mfma_f32_16x16x32_bf16 v[16:19], a[72:75], a[20:23], v[16:19]
    v_mfma_f32_16x16x32_bf16 v[48:51], a[72:75], a[24:27], v[48:51]
    s_waitcnt lgkmcnt(13)
    v_mfma_f32_16x16x32_bf16 v[80:83], a[72:75], a[28:31], v[80:83]
    v_mfma_f32_16x16x32_bf16 v[112:115], a[72:75], a[32:35], v[112:115]
    s_cmp_eq_u32 s60, 0
    s_cbranch_scc1 L_q_alt2
    s_waitcnt vmcnt(12) lgkmcnt(0)
L_q_alt_ret2:
    s_barrier
    v_mfma_f32_16x16x32_bf16 v[20:23], a[76:79], a[20:23], v[20:23]
    ds_read_b64_tr_b16 a[40:41], v246 offset:0
    v_mfma_f32_16x16x32_bf16 v[52:55], a[76:79], a[24:27], v[52:55]
    s_add_u32 m0, s54, 0
    ds_read_b64_tr_b16 a[42:43], v246 offset:3840
    v_mfma_f32_16x16x32_bf16 v[84:87], a[76:79], a[28:31], v[84:87]
    buffer_load_dwordx4 v4, s[20:23], s55 offen lds
    v_mfma_f32_16x16x32_bf16 v[116:119], a[76:79], a[32:35], v[116:119]
    ds_read_b128 a[0:3], v244 offset:10240
    v_mfma_f32_16x16x32_bf16 v[24:27], a[80:83], a[20:23], v[24:27]
    ds_read_b128 a[4:7], v244 offset:12288
    v_mfma_f32_16x16x32_bf16 v[56:59], a[80:83], a[24:27], v[56:59]
    s_add_u32 m0, s54, 4096
    ds_read_b128 a[8:11], v244 offset:14336
    v_mfma_f32_16x16x32_bf16 v[88:91], a[80:83], a[28:31], v[88:91]
    buffer_load_dwordx4 v5, s[20:23], s55 offen lds
    v_mfma_f32_16x16x32_bf16 v[120:123], a[80:83], a[32:35], v[120:123]
    ds_read_b128 a[12:15], v244 offset:16384
    v_mfma_f32_16x16x32_bf16 v[28:31], a[84:87], a[20:23], v[28:31]
    ds_read_b64_tr_b16 a[44:45], v246 offset:32
    v_mfma_f32_16x16x32_bf16 v[60:63], a[84:87], a[24:27], v[60:63]
    s_add_u32 m0, s54, 30720
    ds_read_b64_tr_b16 a[46:47], v246 offset:3872
    v_mfma_f32_16x16x32_bf16 v[92:95], a[84:87], a[28:31], v[92:95]
    buffer_load_dwordx4 v12, s[16:19], s56 offen lds
    v_mfma_f32_16x16x32_bf16 v[124:127], a[84:87], a[32:35], v[124:127]
    ds_read_b64_tr_b16 a[48:49], v246 offset:64
    v_mfma_f32_16x16x32_bf16 v[32:35], a[88:91], a[20:23], v[32:35]
    ds_read_b64_tr_b16 a[50:51], v246 offset:3904
    v_mfma_f32_16x16x32_bf16 v[64:67], a[88:91], a[24:27], v[64:67]
    s_add_u32 m0, s54, 8192
    ds_read_b64_tr_b16 a[52:53], v246 offset:96
    v_mfma_f32_16x16x32_bf16 v[96:99], a[88:91], a[28:31], v[96:99]
    buffer_load_dwordx4 v6, s[20:23], s55 offen lds
    v_mfma_f32_16x16x32_bf16 v[128:131], a[88:91], a[32:35], v[128:131]
    ds_read_b64_tr_b16 a[54:55], v246 offset:3936
    v_mfma_f32_16x16x32_bf16 v[36:39], a[92:95], a[20:23], v[36:39]
    s_add_u32 m0, s54, 34816
    ds_read_b64_tr_b16 a[56:57], v246 offset:128
    v_mfma_f32_16x16x32_bf16 v[68:71], a[92:95], a[24:27], v[68:71]
    buffer_load_dwordx4 v13, s[16:19], s56 offen lds
    v_mfma_f32_16x16x32_bf16 v[100:103], a[92:95], a[28:31], v[100:103]
    ds_read_b64_tr_b16 a[58:59], v246 offset:3968
    v_mfma_f32_16x16x32_bf16 v[132:135], a[92:95], a[32:35], v[132:135]
    ds_read_b64_tr_b16 a[60:61], v246 offset:160
    v_mfma_f32_16x16x32_bf16 v[40:43], a[96:99], a[20:23], v[40:43]
    s_add_u32 m0, s54, 12288
    ds_read_b64_tr_b16 a[62:63], v246 offset:4000
    v_mfma_f32_16x16x32_bf16 v[72:75], a[96:99], a[24:27], v[72:75]
    buffer_load_dwordx4 v7, s[20:23], s55 offen lds
    v_mfma_f32_16x16x32_bf16 v[104:107], a[96:99], a[28:31], v[104:107]
    ds_read_b128 a[16:19], v244
    v_mfma_f32_16x16x32_bf16 v[136:139], a[96:99], a[32:35], v[136:139]
    ds_read_b64_tr_b16 a[64:65], v246 offset:192
    v_mfma_f32_16x16x32_bf16 v[144:147], a[96:99], a[36:39], v[144:147]
    s_add_u32 m0, s54, 16384
    ds_read_b64_tr_b16 a[66:67], v246 offset:4032
    v_mfma_f32_16x16x32_bf16 v[44:47], a[100:103], a[20:23], v[44:47]
    buffer_load_dwordx4 v8, s[20:23], s55 offen lds
    v_mfma_f32_16x16x32_bf16 v[76:79], a[100:103], a[24:27], v[76:79]
    ds_read_b64_tr_b16 a[68:69], v246 offset:224
    v_mfma_f32_16x16x32_bf16 v[108:111], a[100:103], a[28:31], v[108:111]
    ds_read_b64_tr_b16 a[70:71], v246 offset:4064
    s_add_u32 s60, s60, 1
    v_mfma_f32_16x16x32_bf16 v[140:143], a[100:103], a[32:35], v[140:143]
    s_cmp_lt_u32 s60, 10
    s_cbranch_scc1 L_q_loop2
    s_waitcnt vmcnt(0) lgkmcnt(0)
    s_barrier
    s_mul_i32 s61, s96, 5120
    s_mul_i32 s62, s50, 40960
    s_add_u32 s61, s61, s62
    v_lshlrev_b32 v240, 4, v1
    v_add_u32 v244, 0, v240
    v_add_u32 v240, s61, v240
    v_add_u32 v241, 4096, v240
    s_mul_i32 s61, s95, 303104
    s_lshl_b32 s62, s50, 10
    s_add_u32 s61, s61, s62
    v_add_u32 v244, s61, v244
    v_add_u32 v245, 75776, v244
    v_add_u32 v246, 151552, v244
    v_add_u32 v247, 227328, v244
    v_lshlrev_b32 v9, 3, v1
    v_add_u32 v8, 10240, v9
    v_cvt_pk_bf16_f32 v248, v144, v145
    v_cvt_pk_bf16_f32 v249, v146, v147
    ds_write_b64 v9, v[248:249] offset:23552
    s_branch L_q_ex0
L_q_wave3:
    ds_read_b64_tr_b16 a[40:41], v246 offset:256
    ds_read_b64_tr_b16 a[42:43], v246 offset:4096
    ds_read_b128 a[0:3], v244 offset:10240
    ds_read_b128 a[4:7], v244 offset:12288
    ds_read_b128 a[8:11], v244 offset:14336
    ds_read_b128 a[12:15], v244 offset:16384
    ds_read_b64_tr_b16 a[44:45], v246 offset:288
    ds_read_b64_tr_b16 a[46:47], v246 offset:4128
    ds_read_b64_tr_b16 a[48:49], v246 offset:320
    ds_read_b64_tr_b16 a[50:51], v246 offset:4160
    ds_read_b64_tr_b16 a[52:53], v246 offset:352
    ds_read_b64_tr_b16 a[54:55], v246 offset:4192
    ds_read_b128 a[16:19], v244
    ds_read_b64_tr_b16 a[56:57], v246 offset:384
    ds_read_b64_tr_b16 a[58:59], v246 offset:4224
    ds_read_b64_tr_b16 a[60:61], v246 offset:416
    ds_read_b64_tr_b16 a[62:63], v246 offset:4256
    ds_read_b64_tr_b16 a[64:65], v246 offset:448
    ds_read_b64_tr_b16 a[66:67], v246 offset:4288
    ds_read_b64_tr_b16 a[68:69], v246 offset:224
    ds_read_b64_tr_b16 a[70:71], v246 offset:4064
    s_waitcnt lgkmcnt(15)
    v_mfma_f32_16x16x32_bf16 v[16:19], a[40:43], a[0:3], 0
    s_add_u32 m0, s54, 0
    ds_read_b64_tr_b16 a[72:73], v246 offset:15616
    v_mfma_f32_16x16x32_bf16 v[48:51], a[40:43], a[4:7], 0
    buffer_load_dwordx4 v4, s[20:23], s55 offen lds
    v_mfma_f32_16x16x32_bf16 v[80:83], a[40:43], a[8:11], 0
    s_add_u32 m0, s54, 4096
    ds_read_b64_tr_b16 a[74:75], v246 offset:19456
    v_mfma_f32_16x16x32_bf16 v[112:115], a[40:43], a[12:15], 0
    buffer_load_dwordx4 v5, s[20:23], s55 offen lds
    s_waitcnt lgkmcnt(15)
    v_mfma_f32_16x16x32_bf16 v[20:23], a[44:47], a[0:3], 0
    s_add_u32 m0, s54, 30720
    ds_read_b128 a[20:23], v245 offset:10240
    v_mfma_f32_16x16x32_bf16 v[52:55], a[44:47], a[4:7], 0
    buffer_load_dwordx4 v12, s[16:19], s56 offen lds
    v_mfma_f32_16x16x32_bf16 v[84:87], a[44:47], a[8:11], 0
    s_add_u32 m0, s54, 8192
    ds_read_b128 a[24:27], v245 offset:12288
    v_mfma_f32_16x16x32_bf16 v[116:119], a[44:47], a[12:15], 0
    buffer_load_dwordx4 v6, s[20:23], s55 offen lds
    s_waitcnt lgkmcnt(15)
    v_mfma_f32_16x16x32_bf16 v[24:27], a[0:3], a[48:51], 0
    s_add_u32 m0, s54, 34816
    ds_read_b128 a[28:31], v245 offset:14336
    v_mfma_f32_16x16x32_bf16 v[56:59], a[4:7], a[48:51], 0
    buffer_load_dwordx4 v13, s[16:19], s56 offen lds
    s_add_u32 m0, s54, 12288
    v_mfma_f32_16x16x32_bf16 v[88:91], a[8:11], a[48:51], 0
    buffer_load_dwordx4 v7, s[20:23], s55 offen lds
    v_mfma_f32_16x16x32_bf16 v[120:123], a[12:15], a[48:51], 0
    s_add_u32 m0, s54, 16384
    ds_read_b128 a[32:35], v245 offset:16384
    s_waitcnt lgkmcnt(15)
    v_mfma_f32_16x16x32_bf16 v[28:31], a[0:3], a[52:55], 0
    buffer_load_dwordx4 v8, s[20:23], s55 offen lds
    v_mfma_f32_16x16x32_bf16 v[60:63], a[4:7], a[52:55], 0
    ds_read_b64_tr_b16 a[76:77], v246 offset:15648
    v_mfma_f32_16x16x32_bf16 v[92:95], a[8:11], a[52:55], 0
    buffer_load_dwordx4 v[208:211], v212, s[20:23], 0 offen
    v_mfma_f32_16x16x32_bf16 v[124:127], a[12:15], a[52:55], 0
    v_add_u32 v212, 4096, v212
    ds_read_b64_tr_b16 a[78:79], v246 offset:19488
    s_waitcnt lgkmcnt(14)
    v_mfma_f32_16x16x32_bf16 v[32:35], a[0:3], a[56:59], 0
    buffer_load_dwordx4 v[208:211], v212, s[20:23], 0 offen
    v_mfma_f32_16x16x32_bf16 v[64:67], a[4:7], a[56:59], 0
    v_add_u32 v212, 4096, v212
    ds_read_b64_tr_b16 a[80:81], v246 offset:15680
    v_mfma_f32_16x16x32_bf16 v[96:99], a[8:11], a[56:59], 0
    buffer_load_dwordx4 v[208:211], v212, s[20:23], 0 offen
    v_mfma_f32_16x16x32_bf16 v[128:131], a[12:15], a[56:59], 0
    v_add_u32 v212, 4096, v212
    ds_read_b64_tr_b16 a[82:83], v246 offset:19520
    v_mfma_f32_16x16x32_bf16 v[148:151], a[16:19], a[56:59], 0
    buffer_load_dwordx4 v[208:211], v212, s[20:23], 0 offen
    s_add_u32 m0, s54, 20480
    s_waitcnt lgkmcnt(14)
    v_mfma_f32_16x16x32_bf16 v[36:39], a[0:3], a[60:63], 0
    buffer_load_dwordx4 v9, s[20:23], s55 offen lds
    v_mfma_f32_16x16x32_bf16 v[68:71], a[4:7], a[60:63], 0
    s_add_u32 m0, s54, 38912
    ds_read_b64_tr_b16 a[84:85], v246 offset:15712
    v_mfma_f32_16x16x32_bf16 v[100:103], a[8:11], a[60:63], 0
    buffer_load_dwordx4 v14, s[16:19], s56 offen lds
    v_mfma_f32_16x16x32_bf16 v[132:135], a[12:15], a[60:63], 0
    s_add_u32 m0, s54, 24576
    ds_read_b64_tr_b16 a[86:87], v246 offset:19552
    v_mfma_f32_16x16x32_bf16 v[152:155], a[16:19], a[60:63], 0
    buffer_load_dwordx4 v10, s[20:23], s55 offen lds
    s_waitcnt lgkmcnt(14)
    v_mfma_f32_16x16x32_bf16 v[40:43], a[0:3], a[64:67], 0
    s_add_u32 m0, s54, s58
    ds_read_b128 a[36:39], v245
    v_mfma_f32_16x16x32_bf16 v[72:75], a[4:7], a[64:67], 0
    buffer_load_dwordx4 v11, s[24:27], s57 offen lds
    v_mfma_f32_16x16x32_bf16 v[104:107], a[8:11], a[64:67], 0
    s_add_u32 m0, s54, 43008
    ds_read_b64_tr_b16 a[88:89], v246 offset:15744
    v_mfma_f32_16x16x32_bf16 v[136:139], a[12:15], a[64:67], 0
    buffer_load_dwordx4 v15, s[16:19], s56 offen lds
    v_mfma_f32_16x16x32_bf16 v[156:159], a[16:19], a[64:67], 0
    ds_read_b64_tr_b16 a[90:91], v246 offset:19584
    s_waitcnt lgkmcnt(15)
    v_mfma_f32_16x16x32_bf16 v[144:147], a[68:71], a[16:19], 0
    ds_read_b64_tr_b16 a[92:93], v246 offset:15776
    ds_read_b64_tr_b16 a[94:95], v246 offset:19616
    ds_read_b64_tr_b16 a[96:97], v246 offset:15808
    ds_read_b64_tr_b16 a[98:99], v246 offset:19648
    ds_read_b64_tr_b16 a[100:101], v246 offset:15584
    ds_read_b64_tr_b16 a[102:103], v246 offset:19424
    s_add_u32 s54, s53, s67
    s_add_u32 s61, s60, 3
    s_xor_b32 s61, s61, s14
    s_mul_i32 s55, s61, 245760
    s_lshl_b32 s56, s61, 7
    s_mul_i32 s57, s61, s59
    s_cmp_lt_u32 s60, 7
    s_cselect_b32 s22, s65, 0
    s_cselect_b32 s18, s64, 0
    s_cselect_b32 s26, s66, 0
    s_add_u32 s53, s53, 49152
    s_cmp_eq_u32 s53, 147456
    s_cselect_b32 s53, 0, s53
    v_add_u32 v244, s53, v240
    v_add_u32 v246, s53, v242
    s_waitcnt lgkmcnt(15)
    s_branch L_q_loop3_B
L_q_loop3:
    s_waitcnt lgkmcnt(15)
    v_mfma_f32_16x16x32_bf16 v[16:19], a[40:43], a[0:3], v[16:19]
    ds_read_b64_tr_b16 a[72:73], v246 offset:15616
    v_mfma_f32_16x16x32_bf16 v[48:51], a[40:43], a[4:7], v[48:51]
    ds_read_b64_tr_b16 a[74:75], v246 offset:19456
    v_mfma_f32_16x16x32_bf16 v[80:83], a[40:43], a[8:11], v[80:83]
    s_add_u32 m0, s54, 20480
    ds_read_b128 a[20:23], v245 offset:10240
    v_mfma_f32_16x16x32_bf16 v[112:115], a[40:43], a[12:15], v[112:115]
    buffer_load_dwordx4 v9, s[20:23], s55 offen lds
    s_waitcnt lgkmcnt(15)
    v_mfma_f32_16x16x32_bf16 v[20:23], a[44:47], a[0:3], v[20:23]
    ds_read_b128 a[24:27], v245 offset:12288
    v_mfma_f32_16x16x32_bf16 v[52:55], a[44:47], a[4:7], v[52:55]
    ds_read_b128 a[28:31], v245 offset:14336
    v_mfma_f32_16x16x32_bf16 v[84:87], a[44:47], a[8:11], v[84:87]
    s_add_u32 m0, s54, 38912
    ds_read_b128 a[32:35], v245 offset:16384
    v_mfma_f32_16x16x32_bf16 v[116:119], a[44:47], a[12:15], v[116:119]
    buffer_load_dwordx4 v14, s[16:19], s56 offen lds
    s_waitcnt lgkmcnt(15)
    v_mfma_f32_16x16x32_bf16 v[24:27], a[0:3], a[48:51], v[24:27]
    ds_read_b64_tr_b16 a[76:77], v246 offset:15648
    v_mfma_f32_16x16x32_bf16 v[56:59], a[4:7], a[48:51], v[56:59]
    ds_read_b64_tr_b16 a[78:79], v246 offset:19488
    v_mfma_f32_16x16x32_bf16 v[88:91], a[8:11], a[48:51], v[88:91]
    s_add_u32 m0, s54, 24576
    ds_read_b64_tr_b16 a[80:81], v246 offset:15680
    v_mfma_f32_16x16x32_bf16 v[120:123], a[12:15], a[48:51], v[120:123]
    buffer_load_dwordx4 v10, s[20:23], s55 offen lds
    v_mfma_f32_16x16x32_bf16 v[28:31], a[0:3], a[52:55], v[28:31]
    ds_read_b64_tr_b16 a[82:83], v246 offset:19520
    v_mfma_f32_16x16x32_bf16 v[60:63], a[4:7], a[52:55], v[60:63]
    ds_read_b64_tr_b16 a[84:85], v246 offset:15712
    v_mfma_f32_16x16x32_bf16 v[92:95], a[8:11], a[52:55], v[92:95]
    s_add_u32 m0, s54, s58
    ds_read_b64_tr_b16 a[86:87], v246 offset:19552
    v_mfma_f32_16x16x32_bf16 v[124:127], a[12:15], a[52:55], v[124:127]
    buffer_load_dwordx4 v11, s[24:27], s57 offen lds
    s_waitcnt lgkmcnt(15)
    v_mfma_f32_16x16x32_bf16 v[32:35], a[0:3], a[56:59], v[32:35]
    ds_read_b128 a[36:39], v245
    v_mfma_f32_16x16x32_bf16 v[64:67], a[4:7], a[56:59], v[64:67]
    ds_read_b64_tr_b16 a[88:89], v246 offset:15744
    v_mfma_f32_16x16x32_bf16 v[96:99], a[8:11], a[56:59], v[96:99]
    s_add_u32 m0, s54, 43008
    ds_read_b64_tr_b16 a[90:91], v246 offset:19584
    v_mfma_f32_16x16x32_bf16 v[128:131], a[12:15], a[56:59], v[128:131]
    buffer_load_dwordx4 v15, s[16:19], s56 offen lds
    v_mfma_f32_16x16x32_bf16 v[148:151], a[16:19], a[56:59], v[148:151]
    ds_read_b64_tr_b16 a[92:93], v246 offset:15776
    v_mfma_f32_16x16x32_bf16 v[36:39], a[0:3], a[60:63], v[36:39]
    ds_read_b64_tr_b16 a[94:95], v246 offset:19616
    v_mfma_f32_16x16x32_bf16 v[68:71], a[4:7], a[60:63], v[68:71]
    ds_read_b64_tr_b16 a[96:97], v246 offset:15808
    v_mfma_f32_16x16x32_bf16 v[100:103], a[8:11], a[60:63], v[100:103]
    ds_read_b64_tr_b16 a[98:99], v246 offset:19648
    v_mfma_f32_16x16x32_bf16 v[132:135], a[12:15], a[60:63], v[132:135]
    ds_read_b64_tr_b16 a[100:101], v246 offset:15584
    v_mfma_f32_16x16x32_bf16 v[152:155], a[16:19], a[60:63], v[152:155]
    ds_read_b64_tr_b16 a[102:103], v246 offset:19424
    s_add_u32 s54, s53, s67
    s_waitcnt lgkmcnt(15)
    v_mfma_f32_16x16x32_bf16 v[40:43], a[0:3], a[64:67], v[40:43]
    s_add_u32 s61, s60, 3
    s_xor_b32 s61, s61, s14
    s_mul_i32 s55, s61, 245760
    v_mfma_f32_16x16x32_bf16 v[72:75], a[4:7], a[64:67], v[72:75]
    s_lshl_b32 s56, s61, 7
    s_mul_i32 s57, s61, s59
    s_cmp_lt_u32 s60, 7
    v_mfma_f32_16x16x32_bf16 v[104:107], a[8:11], a[64:67], v[104:107]
    s_cselect_b32 s22, s65, 0
    s_cselect_b32 s18, s64, 0
    s_cselect_b32 s26, s66, 0
    v_mfma_f32_16x16x32_bf16 v[136:139], a[12:15], a[64:67], v[136:139]
    s_add_u32 s53, s53, 49152
    s_cmp_eq_u32 s53, 147456
    s_cselect_b32 s53, 0, s53
    v_mfma_f32_16x16x32_bf16 v[156:159], a[16:19], a[64:67], v[156:159]
    v_add_u32 v244, s53, v240
    v_mfma_f32_16x16x32_bf16 v[144:147], a[68:71], a[16:19], v[144:147]
    v_add_u32 v246, s53, v242
L_q_loop3_B:
    v_mfma_f32_16x16x32_bf16 v[16:19], a[72:75], a[20:23], v[16:19]
    v_add_u32 v245, s53, v241
    v_mfma_f32_16x16x32_bf16 v[48:51], a[72:75], a[24:27], v[48:51]
    v_mfma_f32_16x16x32_bf16 v[80:83], a[72:75], a[28:31], v[80:83]
    v_mfma_f32_16x16x32_bf16 v[112:115], a[72:75], a[32:35], v[112:115]
    s_cmp_eq_u32 s60, 0
    s_cbranch_scc1 L_q_alt3
    s_waitcnt vmcnt(12) lgkmcnt(0)
L_q_alt_ret3:
    s_barrier
    v_mfma_f32_16x16x32_bf16 v[20:23], a[76:79], a[20:23], v[20:23]
    ds_read_b64_tr_b16 a[40:41], v246 offset:256
    v_mfma_f32_16x16x32_bf16 v[52:55], a[76:79], a[24:27], v[52:55]
    s_add_u32 m0, s54, 0
    ds_read_b64_tr_b16 a[42:43], v246 offset:4096
    v_mfma_f32_16x16x32_bf16 v[84:87], a[76:79], a[28:31], v[84:87]
    buffer_load_dwordx4 v4, s[20:23], s55 offen lds
    v_mfma_f32_16x16x32_bf16 v[116:119], a[76:79], a[32:35], v[116:119]
    ds_read_b128 a[0:3], v244 offset:10240
    v_mfma_f32_16x16x32_bf16 v[24:27], a[20:23], a[80:83], v[24:27]
    ds_read_b128 a[4:7], v244 offset:12288
    v_mfma_f32_16x16x32_bf16 v[56:59], a[24:27], a[80:83], v[56:59]
    s_add_u32 m0, s54, 4096
    ds_read_b128 a[8:11], v244 offset:14336
    v_mfma_f32_16x16x32_bf16 v[88:91], a[28:31], a[80:83], v[88:91]
    buffer_load_dwordx4 v5, s[20:23], s55 offen lds
    v_mfma_f32_16x16x32_bf16 v[120:123], a[32:35], a[80:83], v[120:123]
    ds_read_b128 a[12:15], v244 offset:16384
    v_mfma_f32_16x16x32_bf16 v[28:31], a[20:23], a[84:87], v[28:31]
    s_add_u32 m0, s54, 30720
    ds_read_b64_tr_b16 a[44:45], v246 offset:288
    v_mfma_f32_16x16x32_bf16 v[60:63], a[24:27], a[84:87], v[60:63]
    buffer_load_dwordx4 v12, s[16:19], s56 offen lds
    v_mfma_f32_16x16x32_bf16 v[92:95], a[28:31], a[84:87], v[92:95]
    ds_read_b64_tr_b16 a[46:47], v246 offset:4128
    v_mfma_f32_16x16x32_bf16 v[124:127], a[32:35], a[84:87], v[124:127]
    ds_read_b64_tr_b16 a[48:49], v246 offset:320
    v_mfma_f32_16x16x32_bf16 v[32:35], a[20:23], a[88:91], v[32:35]
    s_add_u32 m0, s54, 8192
    ds_read_b64_tr_b16 a[50:51], v246 offset:4160
    v_mfma_f32_16x16x32_bf16 v[64:67], a[24:27], a[88:91], v[64:67]
    buffer_load_dwordx4 v6, s[20:23], s55 offen lds
    v_mfma_f32_16x16x32_bf16 v[96:99], a[28:31], a[88:91], v[96:99]
    ds_read_b64_tr_b16 a[52:53], v246 offset:352
    v_mfma_f32_16x16x32_bf16 v[128:131], a[32:35], a[88:91], v[128:131]
    ds_read_b64_tr_b16 a[54:55], v246 offset:4192
    v_mfma_f32_16x16x32_bf16 v[148:151], a[36:39], a[88:91], v[148:151]
    s_add_u32 m0, s54, 34816
    ds_read_b128 a[16:19], v244
    v_mfma_f32_16x16x32_bf16 v[36:39], a[20:23], a[92:95], v[36:39]
    buffer_load_dwordx4 v13, s[16:19], s56 offen lds
    v_mfma_f32_16x16x32_bf16 v[68:71], a[24:27], a[92:95], v[68:71]
    ds_read_b64_tr_b16 a[56:57], v246 offset:384
    v_mfma_f32_16x16x32_bf16 v[100:103], a[28:31], a[92:95], v[100:103]
    s_add_u32 m0, s54, 12288
    ds_read_b64_tr_b16 a[58:59], v246 offset:4224
    v_mfma_f32_16x16x32_bf16 v[132:135], a[32:35], a[92:95], v[132:135]
    buffer_load_dwordx4 v7, s[20:23], s55 offen lds
    v_mfma_f32_16x16x32_bf16 v[152:155], a[36:39], a[92:95], v[152:155]
    ds_read_b64_tr_b16 a[60:61], v246 offset:416
    v_mfma_f32_16x16x32_bf16 v[40:43], a[20:23], a[96:99], v[40:43]
    ds_read_b64_tr_b16 a[62:63], v246 offset:4256
    v_mfma_f32_16x16x32_bf16 v[72:75], a[24:27], a[96:99], v[72:75]
    s_add_u32 m0, s54, 16384
    ds_read_b64_tr_b16 a[64:65], v246 offset:448
    v_mfma_f32_16x16x32_bf16 v[104:107], a[28:31], a[96:99], v[104:107]
    buffer_load_dwordx4 v8, s[20:23], s55 offen lds
    v_mfma_f32_16x16x32_bf16 v[136:139], a[32:35], a[96:99], v[136:139]
    ds_read_b64_tr_b16 a[66:67], v246 offset:4288
    v_mfma_f32_16x16x32_bf16 v[156:159], a[36:39], a[96:99], v[156:159]
    ds_read_b64_tr_b16 a[68:69], v246 offset:224
    v_mfma_f32_16x16x32_bf16 v[144:147], a[100:103], a[36:39], v[144:147]
    ds_read_b64_tr_b16 a[70:71], v246 offset:4064
    s_add_u32 s60, s60, 1
    s_cmp_lt_u32 s60, 10
    s_cbranch_scc1 L_q_loop3
    s_waitcnt vmcnt(0) lgkmcnt(0)
    s_barrier
    s_mul_i32 s61, s96, 5120
    s_mul_i32 s62, s50, 40960
    s_add_u32 s61, s61, s62
    v_lshlrev_b32 v240, 4, v1
    v_add_u32 v244, 0, v240
    v_add_u32 v240, s61, v240
    v_add_u32 v241, 4096, v240
    s_mul_i32 s61, s95, 303104
    s_lshl_b32 s62, s50, 10
    s_add_u32 s61, s61, s62
    v_add_u32 v244, s61, v244
    v_add_u32 v245, 75776, v244
    v_add_u32 v246, 151552, v244
    v_add_u32 v247, 227328, v244
    v_lshlrev_b32 v9, 3, v1
    v_add_u32 v8, 10240, v9
    v_cvt_pk_bf16_f32 v248, v144, v145
    v_cvt_pk_bf16_f32 v249, v146, v147
    ds_write_b64 v9, v[248:249] offset:24064
    v_cvt_pk_bf16_f32 v250, v148, v149
    v_cvt_pk_bf16_f32 v251, v150, v151
    ds_write_b64 v9, v[250:251] offset:47104
    v_cvt_pk_bf16_f32 v252, v152, v153
    v_cvt_pk_bf16_f32 v253, v154, v155
    ds_write_b64 v9, v[252:253] offset:47616
    v_cvt_pk_bf16_f32 v254, v156, v157
    v_cvt_pk_bf16_f32 v255, v158, v159
    ds_write_b64 v9, v[254:255] offset:48128
    s_branch L_q_ex1
L_q_alt0:
    s_waitcnt vmcnt(16) lgkmcnt(0)
    s_branch L_q_alt_ret0
L_q_alt1:
    s_waitcnt vmcnt(16) lgkmcnt(0)
    s_branch L_q_alt_ret1
L_q_alt2:
    s_waitcnt vmcnt(16) lgkmcnt(0)
    s_branch L_q_alt_ret2
L_q_alt3:
    s_waitcnt vmcnt(16) lgkmcnt(0)
    s_branch L_q_alt_ret3
L_q_hook:
    v_mov_b32 v2, 96
    global_load_dword v161, v2, s[48:49] sc1
    s_branch L_q_hook_ret
L_q_ex0:
    v_cvt_pk_bf16_f32 v248, v80, v81
    v_cvt_pk_bf16_f32 v249, v82, v83
    ds_write_b64 v8, v[248:249] offset:7680
    v_cvt_pk_bf16_f32 v250, v84, v85
    v_cvt_pk_bf16_f32 v251, v86, v87
    ds_write_b64 v8, v[250:251] offset:8192
    v_cvt_pk_bf16_f32 v252, v88, v89
    s_mov_b32 s3, 0
    buffer_load_dwordx4 a[0:3], v240, s[32:35], s3 offen sc1
    v_cvt_pk_bf16_f32 v253, v90, v91
    ds_write_b64 v8, v[252:253] offset:8704
    v_cvt_pk_bf16_f32 v254, v92, v93
    v_cvt_pk_bf16_f32 v255, v94, v95
    ds_write_b64 v8, v[254:255] offset:9216
    v_cvt_pk_bf16_f32 v248, v96, v97
    v_cvt_pk_bf16_f32 v249, v98, v99
    buffer_load_dwordx4 a[4:7], v240, s[32:35], s3 offen offset:1024 sc1
    ds_write_b64 v8, v[248:249] offset:9728
    v_cvt_pk_bf16_f32 v250, v112, v113
    v_cvt_pk_bf16_f32 v251, v114, v115
    ds_write_b64 v8, v[250:251] offset:10240
    v_cvt_pk_bf16_f32 v252, v116, v117
    v_cvt_pk_bf16_f32 v253, v118, v119
    ds_write_b64 v8, v[252:253] offset:10752
    buffer_load_dwordx4 a[8:11], v240, s[32:35], s3 offen offset:2048 sc1
    v_cvt_pk_bf16_f32 v254, v120, v121
    v_cvt_pk_bf16_f32 v255, v122, v123
    ds_write_b64 v8, v[254:255] offset:11264
    v_cvt_pk_bf16_f32 v248, v124, v125
    v_cvt_pk_bf16_f32 v249, v126, v127
    ds_write_b64 v8, v[248:249] offset:11776
    v_cvt_pk_bf16_f32 v250, v128, v129
    buffer_load_dwordx4 a[12:15], v240, s[32:35], s3 offen offset:3072 sc1
    v_cvt_pk_bf16_f32 v251, v130, v131
    ds_write_b64 v8, v[250:251] offset:12288
    v_cvt_pk_bf16_f32 v200, v68, v69
    v_cvt_pk_bf16_f32 v201, v70, v71
    ds_write_b64 v8, v[200:201] offset:28160
    v_cvt_pk_bf16_f32 v202, v72, v73
    v_cvt_pk_bf16_f32 v203, v74, v75
    buffer_load_dwordx4 a[16:19], v241, s[32:35], s3 offen sc1
    ds_write_b64 v8, v[202:203] offset:28672
    v_cvt_pk_bf16_f32 v204, v76, v77
    v_cvt_pk_bf16_f32 v205, v78, v79
    ds_write_b64 v8, v[204:205] offset:29184
    v_cvt_pk_bf16_f32 v250, v100, v101
    v_cvt_pk_bf16_f32 v251, v102, v103
    ds_write_b64 v8, v[250:251] offset:30720
    s_mov_b32 s3, 163840
    buffer_load_dwordx4 a[20:23], v240, s[32:35], s3 offen sc1
    v_cvt_pk_bf16_f32 v252, v104, v105
    v_cvt_pk_bf16_f32 v253, v106, v107
    ds_write_b64 v8, v[252:253] offset:31232
    v_cvt_pk_bf16_f32 v254, v108, v109
    v_cvt_pk_bf16_f32 v255, v110, v111
    ds_write_b64 v8, v[254:255] offset:31744
    v_cvt_pk_bf16_f32 v248, v132, v133
    buffer_load_dwordx4 a[24:27], v240, s[32:35], s3 offen offset:1024 sc1
    v_cvt_pk_bf16_f32 v249, v134, v135
    ds_write_b64 v8, v[248:249] offset:33280
    v_cvt_pk_bf16_f32 v250, v136, v137
    v_cvt_pk_bf16_f32 v251, v138, v139
    ds_write_b64 v8, v[250:251] offset:33792
    v_cvt_pk_bf16_f32 v252, v140, v141
    v_cvt_pk_bf16_f32 v253, v142, v143
    buffer_load_dwordx4 a[28:31], v240, s[32:35], s3 offen offset:2048 sc1
    ds_write_b64 v8, v[252:253] offset:34304
    s_waitcnt lgkmcnt(0)
    s_barrier
    ds_read_b64 v[180:181], v8 offset:23040
    ds_read_b64 v[182:183], v8 offset:23552
    ds_read_b64 v[184:185], v8 offset:24064
    ds_read_b64 v[186:187], v8 offset:24576
    buffer_load_dwordx4 a[32:35], v240, s[32:35], s3 offen offset:3072 sc1
    ds_read_b64 v[188:189], v8 offset:25088
    ds_read_b64 v[196:197], v8 offset:27136
    ds_read_b64 v[198:199], v8 offset:27648
    ds_read_b64 v[206:207], v8 offset:29696
    ds_read_b64 v[208:209], v8 offset:30208
    ds_read_b64 v[210:211], v8 offset:46080
    ds_read_b64 v[212:213], v8 offset:48640
    buffer_load_dwordx4 a[36:39], v241, s[32:35], s3 offen sc1
    ds_read_b64 v[214:215], v8 offset:51200
    ds_read_b64 v[216:217], v8 offset:46592
    ds_read_b64 v[218:219], v8 offset:49152
    ds_read_b64 v[220:221], v8 offset:51712
    ds_read_b64 v[222:223], v8 offset:47104
    ds_read_b64 v[224:225], v8 offset:49664
    ds_read_b64 v[226:227], v8 offset:52224
    s_mov_b32 s3, 327680
    buffer_load_dwordx4 a[40:43], v240, s[32:35], s3 offen sc1
    ds_read_b64 v[228:229], v8 offset:47616
    ds_read_b64 v[230:231], v8 offset:50176
    ds_read_b64 v[232:233], v8 offset:52736
    ds_read_b64 v[234:235], v8 offset:48128
    ds_read_b64 v[236:237], v8 offset:50688
    ds_read_b64 v[238:239], v8 offset:53248
    v_cvt_pk_bf16_f32 v190, v36, v37
    buffer_load_dwordx4 a[44:47], v240, s[32:35], s3 offen offset:1024 sc1
    v_cvt_pk_bf16_f32 v191, v38, v39
    v_cvt_pk_bf16_f32 v192, v40, v41
    v_cvt_pk_bf16_f32 v193, v42, v43
    v_cvt_pk_bf16_f32 v194, v44, v45
    v_cvt_pk_bf16_f32 v195, v46, v47
    v_cvt_pk_bf16_f32 v160, v16, v17
    v_cvt_pk_bf16_f32 v161, v18, v19
    buffer_load_dwordx4 a[48:51], v240, s[32:35], s3 offen offset:2048 sc1
    v_cvt_pk_bf16_f32 v162, v20, v21
    v_cvt_pk_bf16_f32 v163, v22, v23
    v_cvt_pk_bf16_f32 v164, v24, v25
    v_cvt_pk_bf16_f32 v165, v26, v27
    v_cvt_pk_bf16_f32 v166, v28, v29
    v_cvt_pk_bf16_f32 v167, v30, v31
    v_cvt_pk_bf16_f32 v168, v32, v33
    buffer_load_dwordx4 a[52:55], v240, s[32:35], s3 offen offset:3072 sc1
    v_cvt_pk_bf16_f32 v169, v34, v35
    v_cvt_pk_bf16_f32 v170, v48, v49
    v_cvt_pk_bf16_f32 v171, v50, v51
    v_cvt_pk_bf16_f32 v172, v52, v53
    v_cvt_pk_bf16_f32 v173, v54, v55
    v_cvt_pk_bf16_f32 v174, v56, v57
    v_cvt_pk_bf16_f32 v175, v58, v59
    buffer_load_dwordx4 a[56:59], v241, s[32:35], s3 offen sc1
    v_cvt_pk_bf16_f32 v176, v60, v61
    v_cvt_pk_bf16_f32 v177, v62, v63
    v_cvt_pk_bf16_f32 v178, v64, v65
    v_cvt_pk_bf16_f32 v179, v66, v67
    s_mov_b32 s3, 491520
    buffer_load_dwordx4 a[60:63], v240, s[32:35], s3 offen sc1
    buffer_load_dwordx4 a[64:67], v240, s[32:35], s3 offen offset:1024 sc1
    buffer_load_dwordx4 a[68:71], v240, s[32:35], s3 offen offset:2048 sc1
    s_branch L_q_att
L_q_ex1:
    v_cvt_pk_bf16_f32 v248, v16, v17
    v_cvt_pk_bf16_f32 v249, v18, v19
    ds_write_b64 v8, v[248:249] offset:27136
    v_cvt_pk_bf16_f32 v250, v20, v21
    v_cvt_pk_bf16_f32 v251, v22, v23
    ds_write_b64 v8, v[250:251] offset:27648
    v_cvt_pk_bf16_f32 v252, v24, v25
    s_mov_b32 s3, 0
    buffer_load_dwordx4 a[0:3], v240, s[32:35], s3 offen sc1
    v_cvt_pk_bf16_f32 v253, v26, v27
    ds_write_b64 v8, v[252:253] offset:48640
    v_cvt_pk_bf16_f32 v254, v28, v29
    v_cvt_pk_bf16_f32 v255, v30, v31
    ds_write_b64 v8, v[254:255] offset:49152
    v_cvt_pk_bf16_f32 v248, v32, v33
    v_cvt_pk_bf16_f32 v249, v34, v35
    buffer_load_dwordx4 a[4:7], v240, s[32:35], s3 offen offset:1024 sc1
    ds_write_b64 v8, v[248:249] offset:49664
    v_cvt_pk_bf16_f32 v250, v36, v37
    v_cvt_pk_bf16_f32 v251, v38, v39
    ds_write_b64 v8, v[250:251] offset:50176
    v_cvt_pk_bf16_f32 v252, v40, v41
    v_cvt_pk_bf16_f32 v253, v42, v43
    ds_write_b64 v8, v[252:253] offset:50688
    buffer_load_dwordx4 a[8:11], v240, s[32:35], s3 offen offset:2048 sc1
    v_cvt_pk_bf16_f32 v186, v48, v49
    v_cvt_pk_bf16_f32 v187, v50, v51
    ds_write_b64 v8, v[186:187] offset:29696
    v_cvt_pk_bf16_f32 v188, v52, v53
    v_cvt_pk_bf16_f32 v189, v54, v55
    ds_write_b64 v8, v[188:189] offset:30208
    v_cvt_pk_bf16_f32 v210, v56, v57
    buffer_load_dwordx4 a[12:15], v240, s[32:35], s3 offen offset:3072 sc1
    v_cvt_pk_bf16_f32 v211, v58, v59
    ds_write_b64 v8, v[210:211] offset:51200
    v_cvt_pk_bf16_f32 v216, v60, v61
    v_cvt_pk_bf16_f32 v217, v62, v63
    ds_write_b64 v8, v[216:217] offset:51712
    v_cvt_pk_bf16_f32 v222, v64, v65
    v_cvt_pk_bf16_f32 v223, v66, v67
    buffer_load_dwordx4 a[16:19], v241, s[32:35], s3 offen sc1
    ds_write_b64 v8, v[222:223] offset:52224
    v_cvt_pk_bf16_f32 v228, v68, v69
    v_cvt_pk_bf16_f32 v229, v70, v71
    ds_write_b64 v8, v[228:229] offset:52736
    v_cvt_pk_bf16_f32 v234, v72, v73
    v_cvt_pk_bf16_f32 v235, v74, v75
    ds_write_b64 v8, v[234:235] offset:53248
    s_mov_b32 s3, 163840
    buffer_load_dwordx4 a[20:23], v240, s[32:35], s3 offen sc1
    v_cvt_pk_bf16_f32 v206, v112, v113
    v_cvt_pk_bf16_f32 v207, v114, v115
    ds_write_b64 v8, v[206:207] offset:34816
    v_cvt_pk_bf16_f32 v208, v116, v117
    v_cvt_pk_bf16_f32 v209, v118, v119
    ds_write_b64 v8, v[208:209] offset:35328
    v_cvt_pk_bf16_f32 v214, v120, v121
    buffer_load_dwordx4 a[24:27], v240, s[32:35], s3 offen offset:1024 sc1
    v_cvt_pk_bf16_f32 v215, v122, v123
    ds_write_b64 v8, v[214:215] offset:56320
    v_cvt_pk_bf16_f32 v220, v124, v125
    v_cvt_pk_bf16_f32 v221, v126, v127
    ds_write_b64 v8, v[220:221] offset:56832
    v_cvt_pk_bf16_f32 v226, v128, v129
    v_cvt_pk_bf16_f32 v227, v130, v131
    buffer_load_dwordx4 a[28:31], v240, s[32:35], s3 offen offset:2048 sc1
    ds_write_b64 v8, v[226:227] offset:57344
    v_cvt_pk_bf16_f32 v232, v132, v133
    v_cvt_pk_bf16_f32 v233, v134, v135
    ds_write_b64 v8, v[232:233] offset:57856
    v_cvt_pk_bf16_f32 v238, v136, v137
    v_cvt_pk_bf16_f32 v239, v138, v139
    ds_write_b64 v8, v[238:239] offset:58368
    buffer_load_dwordx4 a[32:35], v240, s[32:35], s3 offen offset:3072 sc1
    s_waitcnt lgkmcnt(0)
    s_barrier
    ds_read_b64 v[160:161], v8 offset:7680
    ds_read_b64 v[162:163], v8 offset:8192
    ds_read_b64 v[164:165], v8 offset:8704
    ds_read_b64 v[166:167], v8 offset:9216
    ds_read_b64 v[168:169], v8 offset:9728
    buffer_load_dwordx4 a[36:39], v241, s[32:35], s3 offen sc1
    ds_read_b64 v[170:171], v8 offset:10240
    ds_read_b64 v[172:173], v8 offset:10752
    ds_read_b64 v[174:175], v8 offset:11264
    ds_read_b64 v[176:177], v8 offset:11776
    ds_read_b64 v[178:179], v8 offset:12288
    ds_read_b64 v[180:181], v8 offset:28160
    ds_read_b64 v[182:183], v8 offset:28672
    s_mov_b32 s3, 327680
    buffer_load_dwordx4 a[40:43], v240, s[32:35], s3 offen sc1
    ds_read_b64 v[184:185], v8 offset:29184
    ds_read_b64 v[190:191], v8 offset:30720
    ds_read_b64 v[192:193], v8 offset:31232
    ds_read_b64 v[194:195], v8 offset:31744
    ds_read_b64 v[200:201], v8 offset:33280
    ds_read_b64 v[202:203], v8 offset:33792
    ds_read_b64 v[204:205], v8 offset:34304
    buffer_load_dwordx4 a[44:47], v240, s[32:35], s3 offen offset:1024 sc1
    v_cvt_pk_bf16_f32 v196, v80, v81
    v_cvt_pk_bf16_f32 v197, v82, v83
    v_cvt_pk_bf16_f32 v198, v84, v85
    v_cvt_pk_bf16_f32 v199, v86, v87
    v_cvt_pk_bf16_f32 v212, v88, v89
    v_cvt_pk_bf16_f32 v213, v90, v91
    v_cvt_pk_bf16_f32 v218, v92, v93
    buffer_load_dwordx4 a[48:51], v240, s[32:35], s3 offen offset:2048 sc1
    v_cvt_pk_bf16_f32 v219, v94, v95
    v_cvt_pk_bf16_f32 v224, v96, v97
    v_cvt_pk_bf16_f32 v225, v98, v99
    v_cvt_pk_bf16_f32 v230, v100, v101
    v_cvt_pk_bf16_f32 v231, v102, v103
    v_cvt_pk_bf16_f32 v236, v104, v105
    v_cvt_pk_bf16_f32 v237, v106, v107
    buffer_load_dwordx4 a[52:55], v240, s[32:35], s3 offen offset:3072 sc1
    buffer_load_dwordx4 a[56:59], v241, s[32:35], s3 offen sc1
    s_mov_b32 s3, 491520
    buffer_load_dwordx4 a[60:63], v240, s[32:35], s3 offen sc1
    buffer_load_dwordx4 a[64:67], v240, s[32:35], s3 offen offset:1024 sc1
    buffer_load_dwordx4 a[68:71], v240, s[32:35], s3 offen offset:2048 sc1
L_q_att:
    s_mov_b32 s60, 0
    s_load_dwordx2 s[36:37], s[0:1], 56
    s_mov_b32 s16, s28
    s_mov_b32 s17, s29
    s_cmp_lt_u32 s50, 2
    s_cselect_b32 s18, 9699328, 0
    s_mov_b32 s19, 0x20000
    s_mov_b32 s20, s32
    s_mov_b32 s21, s33
    s_cmp_lt_u32 s50, 2
    s_cselect_b32 s22, 3031040, 0
    s_mov_b32 s23, 0x20000
    s_add_u32 s24, s28, 9699328
    s_addc_u32 s25, s29, 0
    s_mov_b32 s26, 131072
    s_mov_b32 s27, 0x20000
    s_waitcnt lgkmcnt(0)
    s_and_b32 s37, s37, 0xffff
    s_mov_b32 s38, 1280
    s_mov_b32 s39, 0x20000
    s_lshr_b32 s63, s95, 1
    s_lshr_b32 s97, s63, 1
    s_lshl_b32 s97, s97, 2
    s_bitcmp1_b32 s63, 0
    s_cselect_b32 s15, 128, 0
    s_add_u32 s97, s97, s15
    s_add_u32 s97, s97, 32
    s_mul_i32 s58, s50, 40960
    v_lshlrev_b32 v242, 4, v1
    v_add_u32 v242, s58, v242
    v_mov_b32 v251, 0x0c0c0100
    v_mov_b32 v252, 0x01000c0c
    v_cndmask_b32 v251, v251, v252, s[68:69]
    v_mov_b32 v253, 0x0c0c0302
    v_mov_b32 v252, 0x03020c0c
    v_cndmask_b32 v253, v253, v252, s[68:69]
    v_mov_b32 v252, 0x0c0c0c0c
    v_cndmask_b32 v4, v251, v252, s[82:83]
    v_cndmask_b32 v6, v252, v251, s[82:83]
    v_cndmask_b32 v5, v253, v252, s[84:85]
    v_cndmask_b32 v7, v252, v253, s[84:85]
    s_lshl_b32 s61, s51, 3
    s_lshl_b32 s62, s50, 1
    s_add_u32 s61, s61, s62
    s_mul_i32 s61, s61, 75776
    v_lshlrev_b32 v10, 4, v1
    v_add_u32 v10, s61, v10
    v_add_u32 v11, 75776, v10
    v_lshlrev_b32 v2, 3, v1
    v_sub_u32 v2, v10, v2
    v_add_u32 v3, 75776, v2
    v_mov_b32 v12, 0xf149f2ca
    s_mov_b32 s63, 0x3ea52b5c
    s_waitcnt lgkmcnt(0)
    s_barrier
    s_waitcnt lgkmcnt(0)
    v_mov_b32 v16, v160
    v_mov_b32 v17, v161
    v_cndmask_b32 v18, 0, v162, s[70:71]
    v_cndmask_b32 v19, 0, v163, s[70:71]
    v_cndmask_b32 v20, 0, v162, s[72:73]
    v_cndmask_b32 v21, 0, v163, s[72:73]
    buffer_load_dwordx4 a[72:75], v240, s[32:35], s3 offen offset:3072 sc1
    v_cndmask_b32 v22, 0, v164, s[74:75]
    v_cndmask_b32 v23, 0, v165, s[74:75]
    v_cndmask_b32 v24, 0, v164, s[76:77]
    v_cndmask_b32 v25, 0, v165, s[76:77]
    v_cndmask_b32 v26, 0, v166, s[78:79]
    v_cndmask_b32 v27, 0, v167, s[78:79]
    v_cndmask_b32 v28, 0, v166, s[80:81]
    buffer_load_dwordx4 a[76:79], v241, s[32:35], s3 offen sc1
    s_waitcnt vmcnt(36)
    v_cndmask_b32 v29, 0, v167, s[80:81]
    v_mov_b32 v30, v168
    v_mov_b32 v31, v169
    v_mov_b32 v32, v170
    v_mov_b32 v33, v171
    v_cndmask_b32 v34, 0, v172, s[70:71]
    v_cndmask_b32 v35, 0, v173, s[70:71]
    s_mov_b32 s3, 655360
    buffer_load_dwordx4 a[80:83], v240, s[32:35], s3 offen sc1
    v_cndmask_b32 v36, 0, v172, s[72:73]
    v_cndmask_b32 v37, 0, v173, s[72:73]
    v_cndmask_b32 v38, 0, v174, s[74:75]
    v_cndmask_b32 v39, 0, v175, s[74:75]
    v_cndmask_b32 v40, 0, v174, s[76:77]
    v_cndmask_b32 v41, 0, v175, s[76:77]
    v_cndmask_b32 v42, 0, v176, s[78:79]
    buffer_load_dwordx4 a[84:87], v240, s[32:35], s3 offen offset:1024 sc1
    v_cndmask_b32 v43, 0, v177, s[78:79]
    v_cndmask_b32 v44, 0, v176, s[80:81]
    v_cndmask_b32 v45, 0, v177, s[80:81]
    v_mov_b32 v46, v178
    v_mov_b32 v47, v179
    v_mfma_f32_16x16x32_bf16 v[48:51], v[180:183], v[16:19], 0
    v_mfma_f32_16x16x32_bf16 v[52:55], v[190:193], v[16:19], 0
    buffer_load_dwordx4 a[88:91], v240, s[32:35], s3 offen offset:2048 sc1
    v_mfma_f32_16x16x32_bf16 v[56:59], v[182:185], v[20:23], 0
    v_mfma_f32_16x16x32_bf16 v[60:63], v[192:195], v[20:23], 0
    v_mfma_f32_16x16x32_bf16 v[64:67], v[184:187], v[24:27], 0
    v_mfma_f32_16x16x32_bf16 v[68:71], v[194:197], v[24:27], 0
    v_mfma_f32_16x16x32_bf16 v[72:75], v[186:189], v[28:31], 0
    v_mfma_f32_16x16x32_bf16 v[76:79], v[196:199], v[28:31], 0
    v_mfma_f32_16x16x32_bf16 v[80:83], v[190:193], v[32:35], 0
    buffer_load_dwordx4 a[92:95], v240, s[32:35], s3 offen offset:3072 sc1
    v_mfma_f32_16x16x32_bf16 v[84:87], v[200:203], v[32:35], 0
    v_mfma_f32_16x16x32_bf16 v[88:91], v[192:195], v[36:39], 0
    v_mfma_f32_16x16x32_bf16 v[92:95], v[202:205], v[36:39], 0
    v_mfma_f32_16x16x32_bf16 v[96:99], v[194:197], v[40:43], 0
    v_mfma_f32_16x16x32_bf16 v[100:103], v[204:207], v[40:43], 0
    v_mfma_f32_16x16x32_bf16 v[104:107], v[196:199], v[44:47], 0
    v_mfma_f32_16x16x32_bf16 v[108:111], v[206:209], v[44:47], 0
    buffer_load_dwordx4 a[96:99], v241, s[32:35], s3 offen sc1
    v_cndmask_b32 v48, v48, v49, s[68:69]
    v_cndmask_b32 v50, v50, v51, s[68:69]
    v_cndmask_b32 v52, v52, v53, s[68:69]
    v_cndmask_b32 v54, v54, v55, s[68:69]
    v_cndmask_b32 v112, v48, v52, s[82:83]
    v_cndmask_b32 v113, v50, v54, s[84:85]
    v_cndmask_b32 v112, v112, v12, s[86:87]
    s_mov_b32 s3, 819200
    buffer_load_dwordx4 a[100:103], v240, s[32:35], s3 offen sc1
    v_cndmask_b32 v113, v113, v12, s[88:89]
    v_max_f32 v128, v112, v113
    v_cndmask_b32 v56, v56, v57, s[68:69]
    v_cndmask_b32 v58, v58, v59, s[68:69]
    v_cndmask_b32 v60, v60, v61, s[68:69]
    v_cndmask_b32 v62, v62, v63, s[68:69]
    v_cndmask_b32 v114, v56, v60, s[82:83]
    buffer_load_dwordx4 a[104:107], v240, s[32:35], s3 offen offset:1024 sc1
    v_cndmask_b32 v115, v58, v62, s[84:85]
    v_cndmask_b32 v114, v114, v12, s[86:87]
    v_cndmask_b32 v115, v115, v12, s[88:89]
    v_max_f32 v129, v114, v115
    v_cndmask_b32 v64, v64, v65, s[68:69]
    v_cndmask_b32 v66, v66, v67, s[68:69]
    v_cndmask_b32 v68, v68, v69, s[68:69]
    buffer_load_dwordx4 a[108:111], v240, s[32:35], s3 offen offset:2048 sc1
    v_cndmask_b32 v70, v70, v71, s[68:69]
    v_cndmask_b32 v116, v64, v68, s[82:83]
    v_cndmask_b32 v117, v66, v70, s[84:85]
    v_cndmask_b32 v116, v116, v12, s[86:87]
    v_cndmask_b32 v117, v117, v12, s[88:89]
    v_max_f32 v130, v116, v117
    v_cndmask_b32 v72, v72, v73, s[68:69]
    buffer_load_dwordx4 a[112:115], v240, s[32:35], s3 offen offset:3072 sc1
    v_cndmask_b32 v74, v74, v75, s[68:69]
    v_cndmask_b32 v76, v76, v77, s[68:69]
    v_cndmask_b32 v78, v78, v79, s[68:69]
    v_cndmask_b32 v118, v72, v76, s[82:83]
    v_cndmask_b32 v119, v74, v78, s[84:85]
    v_cndmask_b32 v118, v118, v12, s[86:87]
    v_cndmask_b32 v119, v119, v12, s[88:89]
    buffer_load_dwordx4 a[116:119], v241, s[32:35], s3 offen sc1
    v_max_f32 v131, v118, v119
    v_cndmask_b32 v80, v80, v81, s[68:69]
    v_cndmask_b32 v82, v82, v83, s[68:69]
    v_cndmask_b32 v84, v84, v85, s[68:69]
    v_cndmask_b32 v86, v86, v87, s[68:69]
    v_cndmask_b32 v120, v80, v84, s[82:83]
    v_cndmask_b32 v121, v82, v86, s[84:85]
    s_mov_b32 s3, 983040
    buffer_load_dwordx4 a[120:123], v240, s[32:35], s3 offen sc1
    v_max_f32 v132, v120, v121
    v_cndmask_b32 v88, v88, v89, s[68:69]
    v_cndmask_b32 v90, v90, v91, s[68:69]
    v_cndmask_b32 v92, v92, v93, s[68:69]
    v_cndmask_b32 v94, v94, v95, s[68:69]
    v_cndmask_b32 v122, v88, v92, s[82:83]
    v_cndmask_b32 v123, v90, v94, s[84:85]
    buffer_load_dwordx4 a[124:127], v240, s[32:35], s3 offen offset:1024 sc1
    v_max_f32 v133, v122, v123
    v_cndmask_b32 v96, v96, v97, s[68:69]
    v_cndmask_b32 v98, v98, v99, s[68:69]
    v_cndmask_b32 v100, v100, v101, s[68:69]
    v_cndmask_b32 v102, v102, v103, s[68:69]
    v_cndmask_b32 v124, v96, v100, s[82:83]
    v_cndmask_b32 v125, v98, v102, s[84:85]
    buffer_load_dwordx4 a[128:131], v240, s[32:35], s3 offen offset:2048 sc1
    v_max_f32 v134, v124, v125
    v_cndmask_b32 v104, v104, v105, s[68:69]
    v_cndmask_b32 v106, v106, v107, s[68:69]
    v_cndmask_b32 v108, v108, v109, s[68:69]
    v_cndmask_b32 v110, v110, v111, s[68:69]
    v_cndmask_b32 v126, v104, v108, s[82:83]
    v_cndmask_b32 v127, v106, v110, s[84:85]
    buffer_load_dwordx4 a[132:135], v240, s[32:35], s3 offen offset:3072 sc1
    v_max_f32 v135, v126, v127
    v_permlane32_swap_b32 v128, v129
    v_permlane32_swap_b32 v132, v133
    v_permlane32_swap_b32 v130, v131
    v_permlane32_swap_b32 v134, v135
    v_max_f32 v128, v128, v129
    v_max_f32 v132, v132, v133
    buffer_load_dwordx4 a[136:139], v241, s[32:35], s3 offen sc1
    v_max_f32 v130, v130, v131
    v_max_f32 v134, v134, v135
    s_nop 0
    v_permlane16_swap_b32 v128, v130
    v_permlane16_swap_b32 v132, v134
    v_max_f32 v128, v128, v130
    v_max_f32 v132, v132, v134
    v_mov_b32 v130, v128
    s_mov_b32 s3, 1146880
    s_add_u32 m0, s58, 0
    s_nop 0
    buffer_load_dwordx4 v240, s[32:35], s3 offen sc1 lds
    v_mov_b32 v134, v132
    v_permlane16_swap_b32 v128, v130
    s_nop 0
    v_permlane16_swap_b32 v132, v134
    v_mov_b32 v129, v128
    v_mov_b32 v133, v132
    v_mov_b32 v131, v130
    v_mov_b32 v135, v134
    buffer_load_dwordx4 v240, s[32:35], s3 offen offset:1024 sc1 lds
    v_permlane32_swap_b32 v128, v129
    v_permlane32_swap_b32 v132, v133
    v_permlane32_swap_b32 v130, v131
    v_permlane32_swap_b32 v134, v135
    v_mul_f32 v128, s63, v128
    v_fma_f32 v112, v112, s63, -v128
    v_fma_f32 v113, v113, s63, -v128
    buffer_load_dwordx4 v240, s[32:35], s3 offen offset:2048 sc1 lds
    v_mul_f32 v129, s63, v129
    v_fma_f32 v114, v114, s63, -v129
    v_fma_f32 v115, v115, s63, -v129
    v_mul_f32 v130, s63, v130
    v_fma_f32 v116, v116, s63, -v130
    v_fma_f32 v117, v117, s63, -v130
    v_mul_f32 v131, s63, v131
    buffer_load_dwordx4 v240, s[32:35], s3 offen offset:3072 sc1 lds
    v_fma_f32 v118, v118, s63, -v131
    v_fma_f32 v119, v119, s63, -v131
    v_mul_f32 v132, s63, v132
    v_fma_f32 v120, v120, s63, -v132
    v_fma_f32 v121, v121, s63, -v132
    v_mul_f32 v133, s63, v133
    v_fma_f32 v122, v122, s63, -v133
    s_add_u32 m0, s58, 4096
    s_nop 0
    buffer_load_dwordx4 v241, s[32:35], s3 offen sc1 lds
    s_waitcnt vmcnt(36)
    v_fma_f32 v123, v123, s63, -v133
    v_mul_f32 v134, s63, v134
    v_fma_f32 v124, v124, s63, -v134
    v_fma_f32 v125, v125, s63, -v134
    v_mul_f32 v135, s63, v135
    v_fma_f32 v126, v126, s63, -v135
    v_fma_f32 v127, v127, s63, -v135
    s_mov_b32 s3, 1310720
    s_add_u32 m0, s58, 5120
    s_nop 0
    buffer_load_dwordx4 v240, s[32:35], s3 offen sc1 lds
    v_exp_f32 v112, v112
    v_exp_f32 v113, v113
    v_exp_f32 v114, v114
    v_exp_f32 v115, v115
    v_exp_f32 v116, v116
    v_exp_f32 v117, v117
    v_exp_f32 v118, v118
    buffer_load_dwordx4 v240, s[32:35], s3 offen offset:1024 sc1 lds
    v_exp_f32 v119, v119
    v_exp_f32 v120, v120
    v_exp_f32 v121, v121
    v_exp_f32 v122, v122
    v_exp_f32 v123, v123
    v_exp_f32 v124, v124
    v_exp_f32 v125, v125
    buffer_load_dwordx4 v240, s[32:35], s3 offen offset:2048 sc1 lds
    v_exp_f32 v126, v126
    v_exp_f32 v127, v127
    v_add_f32 v136, v112, v113
    v_add_f32 v137, v114, v115
    v_add_f32 v138, v116, v117
    v_add_f32 v139, v118, v119
    v_add_f32 v140, v120, v121
    buffer_load_dwordx4 v240, s[32:35], s3 offen offset:3072 sc1 lds
    v_add_f32 v141, v122, v123
    v_add_f32 v142, v124, v125
    v_add_f32 v143, v126, v127
    v_permlane32_swap_b32 v136, v137
    v_permlane32_swap_b32 v140, v141
    v_permlane32_swap_b32 v138, v139
    v_permlane32_swap_b32 v142, v143
    s_add_u32 m0, s58, 9216
    s_nop 0
    buffer_load_dwordx4 v241, s[32:35], s3 offen sc1 lds
    v_add_f32 v136, v136, v137
    v_add_f32 v140, v140, v141
    v_add_f32 v138, v138, v139
    v_add_f32 v142, v142, v143
    s_nop 0
    v_permlane16_swap_b32 v136, v138
    v_permlane16_swap_b32 v140, v142
    v_add_f32 v136, v136, v138
    s_mov_b32 s3, 1474560
    s_add_u32 m0, s58, 10240
    s_nop 0
    buffer_load_dwordx4 v240, s[32:35], s3 offen sc1 lds
    v_add_f32 v140, v140, v142
    v_mov_b32 v138, v136
    v_mov_b32 v142, v140
    s_nop 0
    v_permlane16_swap_b32 v136, v138
    v_permlane16_swap_b32 v140, v142
    v_mov_b32 v137, v136
    v_mov_b32 v141, v140
    buffer_load_dwordx4 v240, s[32:35], s3 offen offset:1024 sc1 lds
    v_mov_b32 v139, v138
    v_mov_b32 v143, v142
    v_permlane32_swap_b32 v136, v137
    v_permlane32_swap_b32 v140, v141
    v_permlane32_swap_b32 v138, v139
    v_permlane32_swap_b32 v142, v143
    v_rcp_f32 v136, v136
    buffer_load_dwordx4 v240, s[32:35], s3 offen offset:2048 sc1 lds
    v_rcp_f32 v137, v137
    v_rcp_f32 v138, v138
    v_rcp_f32 v139, v139
    v_rcp_f32 v140, v140
    v_rcp_f32 v141, v141
    v_rcp_f32 v142, v142
    v_rcp_f32 v143, v143
    buffer_load_dwordx4 v240, s[32:35], s3 offen offset:3072 sc1 lds
    v_mul_f32 v112, v112, v136
    v_mul_f32 v113, v113, v136
    v_cvt_pk_bf16_f32 v128, v112, v113
    v_mul_f32 v114, v114, v137
    v_mul_f32 v115, v115, v137
    v_cvt_pk_bf16_f32 v129, v114, v115
    v_mul_f32 v116, v116, v138
    s_add_u32 m0, s58, 14336
    s_nop 0
    buffer_load_dwordx4 v241, s[32:35], s3 offen sc1 lds
    v_mul_f32 v117, v117, v138
    v_cvt_pk_bf16_f32 v130, v116, v117
    v_mul_f32 v118, v118, v139
    v_mul_f32 v119, v119, v139
    v_cvt_pk_bf16_f32 v131, v118, v119
    v_mul_f32 v120, v120, v140
    v_mul_f32 v121, v121, v140
    s_mov_b32 s3, 1638400
    s_add_u32 m0, s58, 15360
    s_nop 0
    buffer_load_dwordx4 v240, s[32:35], s3 offen sc1 lds
    v_cvt_pk_bf16_f32 v132, v120, v121
    v_mul_f32 v122, v122, v141
    v_mul_f32 v123, v123, v141
    v_cvt_pk_bf16_f32 v133, v122, v123
    v_mul_f32 v124, v124, v142
    v_mul_f32 v125, v125, v142
    v_cvt_pk_bf16_f32 v134, v124, v125
    buffer_load_dwordx4 v240, s[32:35], s3 offen offset:1024 sc1 lds
    v_mul_f32 v126, v126, v143
    v_mul_f32 v127, v127, v143
    v_cvt_pk_bf16_f32 v135, v126, v127
    v_perm_b32 v16, v128, v128, v4
    v_perm_b32 v17, v128, v128, v5
    v_perm_b32 v18, v128, v128, v6
    v_perm_b32 v19, v128, v128, v7
    buffer_load_dwordx4 v240, s[32:35], s3 offen offset:2048 sc1 lds
    v_perm_b32 v20, v129, v129, v4
    v_perm_b32 v21, v129, v129, v5
    v_perm_b32 v22, v129, v129, v6
    v_perm_b32 v23, v129, v129, v7
    v_perm_b32 v24, v130, v130, v4
    v_perm_b32 v25, v130, v130, v5
    v_perm_b32 v26, v130, v130, v6
    buffer_load_dwordx4 v240, s[32:35], s3 offen offset:3072 sc1 lds
    v_perm_b32 v27, v130, v130, v7
    v_perm_b32 v28, v131, v131, v4
    v_perm_b32 v29, v131, v131, v5
    v_perm_b32 v30, v131, v131, v6
    v_perm_b32 v31, v131, v131, v7
    v_perm_b32 v32, v132, v132, v4
    v_perm_b32 v33, v132, v132, v5
    s_add_u32 m0, s58, 19456
    s_nop 0
    buffer_load_dwordx4 v241, s[32:35], s3 offen sc1 lds
    v_perm_b32 v34, v132, v132, v6
    v_perm_b32 v35, v132, v132, v7
    v_perm_b32 v36, v133, v133, v4
    v_perm_b32 v37, v133, v133, v5
    v_perm_b32 v38, v133, v133, v6
    v_perm_b32 v39, v133, v133, v7
    v_perm_b32 v40, v134, v134, v4
    s_mov_b32 s3, 1802240
    s_add_u32 m0, s58, 20480
    s_nop 0
    buffer_load_dwordx4 v240, s[32:35], s3 offen sc1 lds
    v_perm_b32 v41, v134, v134, v5
    v_perm_b32 v42, v134, v134, v6
    v_perm_b32 v43, v134, v134, v7
    v_perm_b32 v44, v135, v135, v4
    v_perm_b32 v45, v135, v135, v5
    v_perm_b32 v46, v135, v135, v6
    v_perm_b32 v47, v135, v135, v7
    buffer_load_dwordx4 v240, s[32:35], s3 offen offset:1024 sc1 lds
    v_mfma_f32_16x16x32_bf16 v[48:51], v[210:213], v[16:19], 0
    v_mfma_f32_16x16x32_bf16 v[52:55], v[216:219], v[16:19], 0
    v_mfma_f32_16x16x32_bf16 v[56:59], v[216:219], v[20:23], 0
    v_mfma_f32_16x16x32_bf16 v[60:63], v[222:225], v[20:23], 0
    v_mfma_f32_16x16x32_bf16 v[64:67], v[222:225], v[24:27], 0
    v_mfma_f32_16x16x32_bf16 v[68:71], v[228:231], v[24:27], 0
    v_mfma_f32_16x16x32_bf16 v[72:75], v[228:231], v[28:31], 0
    buffer_load_dwordx4 v240, s[32:35], s3 offen offset:2048 sc1 lds
    v_mfma_f32_16x16x32_bf16 v[76:79], v[234:237], v[28:31], 0
    v_mfma_f32_16x16x32_bf16 v[80:83], v[212:215], v[32:35], 0
    v_mfma_f32_16x16x32_bf16 v[84:87], v[218:221], v[32:35], 0
    v_mfma_f32_16x16x32_bf16 v[88:91], v[218:221], v[36:39], 0
    v_mfma_f32_16x16x32_bf16 v[92:95], v[224:227], v[36:39], 0
    v_mfma_f32_16x16x32_bf16 v[96:99], v[224:227], v[40:43], 0
    v_mfma_f32_16x16x32_bf16 v[100:103], v[230:233], v[40:43], 0
    buffer_load_dwordx4 v240, s[32:35], s3 offen offset:3072 sc1 lds
    v_mfma_f32_16x16x32_bf16 v[104:107], v[230:233], v[44:47], 0
    v_mfma_f32_16x16x32_bf16 v[108:111], v[236:239], v[44:47], 0
    v_cvt_pk_bf16_f32 v112, v48, v49
    v_cvt_pk_bf16_f32 v113, v50, v51
    v_cvt_pk_bf16_f32 v114, v52, v53
    v_cvt_pk_bf16_f32 v115, v54, v55
    v_cvt_pk_bf16_f32 v134, v56, v57
    s_add_u32 m0, s58, 24576
    s_nop 0
    buffer_load_dwordx4 v241, s[32:35], s3 offen sc1 lds
    s_waitcnt vmcnt(36)
    v_cvt_pk_bf16_f32 v135, v58, v59
    v_cndmask_b32 v114, v114, v134, s[72:73]
    v_cndmask_b32 v115, v115, v135, s[72:73]
    buffer_store_dwordx4 v[112:115], v10, s[28:31], s90 offen sc1
    v_cvt_pk_bf16_f32 v116, v60, v61
    v_cvt_pk_bf16_f32 v117, v62, v63
    v_cvt_pk_bf16_f32 v132, v64, v65
    s_mov_b32 s3, 1966080
    s_add_u32 m0, s58, 25600
    s_nop 0
    buffer_load_dwordx4 v240, s[32:35], s3 offen sc1 lds
    v_cvt_pk_bf16_f32 v133, v66, v67
    v_cndmask_b32 v116, v116, v132, s[76:77]
    v_cndmask_b32 v117, v117, v133, s[76:77]
    v_cvt_pk_bf16_f32 v118, v68, v69
    v_cvt_pk_bf16_f32 v119, v70, v71
    v_cvt_pk_bf16_f32 v134, v72, v73
    v_cvt_pk_bf16_f32 v135, v74, v75
    buffer_load_dwordx4 v240, s[32:35], s3 offen offset:1024 sc1 lds
    v_cndmask_b32 v118, v118, v134, s[80:81]
    v_cndmask_b32 v119, v119, v135, s[80:81]
    buffer_store_dwordx4 v[116:119], v10, s[28:31], s91 offen sc1
    v_cvt_pk_bf16_f32 v120, v76, v77
    v_cvt_pk_bf16_f32 v121, v78, v79
    buffer_store_dwordx2 v[120:121], v2, s[28:31], s92 offen sc1
    v_cvt_pk_bf16_f32 v122, v80, v81
    buffer_load_dwordx4 v240, s[32:35], s3 offen offset:2048 sc1 lds
    v_cvt_pk_bf16_f32 v123, v82, v83
    v_cvt_pk_bf16_f32 v124, v84, v85
    v_cvt_pk_bf16_f32 v125, v86, v87
    v_cvt_pk_bf16_f32 v134, v88, v89
    v_cvt_pk_bf16_f32 v135, v90, v91
    v_cndmask_b32 v124, v124, v134, s[72:73]
    v_cndmask_b32 v125, v125, v135, s[72:73]
    buffer_load_dwordx4 v240, s[32:35], s3 offen offset:3072 sc1 lds
    buffer_store_dwordx4 v[122:125], v11, s[28:31], s90 offen sc1
    v_cvt_pk_bf16_f32 v126, v92, v93
    v_cvt_pk_bf16_f32 v127, v94, v95
    v_cvt_pk_bf16_f32 v132, v96, v97
    v_cvt_pk_bf16_f32 v133, v98, v99
    v_cndmask_b32 v126, v126, v132, s[76:77]
    v_cndmask_b32 v127, v127, v133, s[76:77]
    s_add_u32 m0, s58, 29696
    s_nop 0
    buffer_load_dwordx4 v241, s[32:35], s3 offen sc1 lds
    v_cvt_pk_bf16_f32 v128, v100, v101
    v_cvt_pk_bf16_f32 v129, v102, v103
    v_cvt_pk_bf16_f32 v134, v104, v105
    v_cvt_pk_bf16_f32 v135, v106, v107
    v_cndmask_b32 v128, v128, v134, s[80:81]
    v_cndmask_b32 v129, v129, v135, s[80:81]
    buffer_store_dwordx4 v[126:129], v11, s[28:31], s91 offen sc1
    s_mov_b32 s3, 2129920
    s_add_u32 m0, s58, 30720
    s_nop 0
    buffer_load_dwordx4 v240, s[20:23], s3 offen sc1 lds
    v_cvt_pk_bf16_f32 v130, v108, v109
    v_cvt_pk_bf16_f32 v131, v110, v111
    buffer_store_dwordx2 v[130:131], v3, s[28:31], s92 offen sc1
    buffer_load_dwordx4 v240, s[20:23], s3 offen offset:1024 sc1 lds
    buffer_load_dwordx4 v240, s[20:23], s3 offen offset:2048 sc1 lds
    buffer_load_dwordx4 v240, s[20:23], s3 offen offset:3072 sc1 lds
    s_add_u32 m0, s58, 34816
    s_nop 0
    buffer_load_dwordx4 v241, s[20:23], s3 offen sc1 lds
    s_mov_b32 s3, 2211840
    s_add_u32 m0, s58, 35840
    s_nop 0
    buffer_load_dwordx4 v240, s[32:35], s3 offen sc1 lds
    s_cmp_lg_u32 s50, 0
    s_cbranch_scc1 L_q_hpoll_iss
    v_mov_b32 v14, s97
    global_load_dword v14, v14, s[48:49] sc1
L_q_hpoll_iss:
    buffer_load_dwordx4 v240, s[32:35], s3 offen offset:1024 sc1 lds
    buffer_load_dwordx4 v240, s[32:35], s3 offen offset:2048 sc1 lds
    s_waitcnt vmcnt(36)
    buffer_load_dwordx4 v240, s[32:35], s3 offen offset:3072 sc1 lds
    s_add_u32 m0, s58, 39936
    s_nop 0
    buffer_load_dwordx4 v241, s[32:35], s3 offen sc1 lds
    v_lshrrev_b32 v3, 4, v1
    s_mul_i32 s61, s96, 160
    v_lshl_add_u32 v3, v3, 3, s61
    buffer_load_dwordx2 v[20:21], v3, s[36:39], 0 offen offset:0
    buffer_load_dwordx2 v[22:23], v3, s[36:39], 0 offen offset:32
    buffer_load_dwordx2 v[24:25], v3, s[36:39], 0 offen offset:64
    buffer_load_dwordx2 v[26:27], v3, s[36:39], 0 offen offset:96
    buffer_load_dwordx2 v[28:29], v3, s[36:39], 0 offen offset:128
    v_mov_b64 v[64:65], 0
    v_mov_b64 v[66:67], 0
    v_mov_b64 v[68:69], 0
    v_mov_b64 v[70:71], 0
    v_mov_b64 v[72:73], 0
    v_mov_b64 v[74:75], 0
    v_mov_b64 v[76:77], 0
    v_mov_b64 v[78:79], 0
    v_mov_b64 v[80:81], 0
    v_mov_b64 v[82:83], 0
    v_mov_b64 v[84:85], 0
    v_mov_b64 v[86:87], 0
    v_mov_b64 v[88:89], 0
    v_mov_b64 v[90:91], 0
    v_mov_b64 v[92:93], 0
    v_mov_b64 v[94:95], 0
    v_mov_b64 v[96:97], 0
    v_mov_b64 v[98:99], 0
    v_mov_b64 v[100:101], 0
    v_mov_b64 v[102:103], 0
    v_mov_b64 v[104:105], 0
    v_mov_b64 v[106:107], 0
    v_mov_b64 v[108:109], 0
    v_mov_b64 v[110:111], 0
    v_mov_b64 v[112:113], 0
    v_mov_b64 v[114:115], 0
    v_mov_b64 v[116:117], 0
    v_mov_b64 v[118:119], 0
    v_mov_b64 v[120:121], 0
    v_mov_b64 v[122:123], 0
    v_mov_b64 v[124:125], 0
    v_mov_b64 v[126:127], 0
    v_mov_b64 v[128:129], 0
    v_mov_b64 v[130:131], 0
    v_mov_b64 v[132:133], 0
    v_mov_b64 v[134:135], 0
    v_mov_b64 v[136:137], 0
    v_mov_b64 v[138:139], 0
    v_mov_b64 v[140:141], 0
    v_mov_b64 v[142:143], 0
    v_mov_b64 v[144:145], 0
    v_mov_b64 v[146:147], 0
    v_mov_b64 v[148:149], 0
    v_mov_b64 v[150:151], 0
    v_mov_b64 v[152:153], 0
    v_mov_b64 v[154:155], 0
    v_mov_b64 v[156:157], 0
    v_mov_b64 v[158:159], 0
    v_mov_b64 v[160:161], 0
    v_mov_b64 v[162:163], 0
    v_mov_b64 v[164:165], 0
    v_mov_b64 v[166:167], 0
    v_mov_b64 v[168:169], 0
    v_mov_b64 v[170:171], 0
    v_mov_b64 v[172:173], 0
    v_mov_b64 v[174:175], 0
    v_mov_b64 v[176:177], 0
    v_mov_b64 v[178:179], 0
    v_mov_b64 v[180:181], 0
    v_mov_b64 v[182:183], 0
    v_mov_b64 v[184:185], 0
    v_mov_b64 v[186:187], 0
    v_mov_b64 v[188:189], 0
    v_mov_b64 v[190:191], 0
    v_mov_b64 v[192:193], 0
    v_mov_b64 v[194:195], 0
    v_mov_b64 v[196:197], 0
    v_mov_b64 v[198:199], 0
    v_mov_b64 v[200:201], 0
    v_mov_b64 v[202:203], 0
    v_mov_b64 v[204:205], 0
    v_mov_b64 v[206:207], 0
    v_mov_b64 v[208:209], 0
    v_mov_b64 v[210:211], 0
    v_mov_b64 v[212:213], 0
    v_mov_b64 v[214:215], 0
    v_mov_b64 v[216:217], 0
    v_mov_b64 v[218:219], 0
    v_mov_b64 v[220:221], 0
    v_mov_b64 v[222:223], 0
    s_lshr_b32 s63, s95, 1
    s_lshr_b32 s62, s63, 1
    s_lshl_b32 s62, s62, 2
    s_bitcmp1_b32 s63, 0
    s_cselect_b32 s15, 128, 0
    s_add_u32 s62, s62, s15
    s_add_u32 s62, s62, 32
    s_cmp_lg_u32 s50, 0
    s_cbranch_scc1 L_q_hpoll_skip
    s_waitcnt vmcnt(9)
    v_readfirstlane_b32 s61, v14
    s_nop 3
    s_cmp_ge_u32 s61, 8
    s_cbranch_scc1 L_q_hpoll_skip
    v_mov_b32 v2, s62
    s_mov_b32 s15, 400000
L_q_hpoll:
    global_load_dword v3, v2, s[48:49] sc1
    s_sub_u32 s15, s15, 1
    s_cbranch_scc1 L_q_hpoll_out
    s_waitcnt vmcnt(0)
    v_readfirstlane_b32 s61, v3
    s_nop 3
    s_cmp_ge_u32 s61, 8
    s_cbranch_scc1 L_q_hpoll_out
    s_sleep 1
    s_branch L_q_hpoll
L_q_hpoll_out:
L_q_hpoll_skip:
    s_barrier
    s_branch L_phase2
L_role_h:
    s_mul_i32 s62, s52, 224
    s_min_u32 s62, s62, 1504
    s_lshl_b32 s63, s62, 1
    v_and_b32 v16, 15, v1
    v_lshrrev_b32 v17, 4, v1
    v_lshrrev_b32 v18, 1, v16
    v_xor_b32 v18, v18, v17
    v_lshlrev_b32 v18, 4, v18
    v_lshl_add_u32 v240, v16, 7, v18
    v_add_u32 v240, 28672, v240
    v_xor_b32 v241, 64, v240
    v_lshrrev_b32 v19, 1, v17
    v_lshlrev_b32 v19, 4, v19
    v_and_b32 v17, 1, v17
    v_lshl_add_u32 v19, v17, 2, v19
    v_lshrrev_b32 v18, 2, v16
    v_add_u32 v19, v19, v18
    v_mul_u32_u24 v19, 448, v19
    v_and_b32 v16, 3, v1
    v_lshl_add_u32 v242, v16, 3, v19
    v_lshlrev_b32 v17, 5, v17
    v_sub_u32 v243, v242, v17
    v_add_u32 v242, v242, v17
    s_cmp_ge_u32 s50, 2
    s_cselect_b64 vcc, -1, 0
    v_add_u32 v16, 224, v242
    v_add_u32 v17, 224, v243
    v_cndmask_b32 v242, v242, v17, vcc
    v_cndmask_b32 v243, v243, v16, vcc
    s_and_b32 s61, s50, 1
    s_lshl_b32 s61, s61, 13
    v_add_u32 v240, s61, v240
    v_add_u32 v241, s61, v241
    s_lshl_b32 s61, s50, 6
    v_add_u32 v24, s61, v1
    v_mul_u32_u24 v17, 2341, v24
    v_lshrrev_b32 v17, 16, v17
    v_mul_u32_u24 v18, 28, v17
    v_sub_u32 v18, v24, v18
    v_lshrrev_b32 v19, 1, v17
    v_and_b32 v19, 2, v19
    v_xor_b32 v18, v18, v19
    v_and_b32 v19, 0x33, v17
    v_and_b32 v20, 4, v17
    v_lshl_add_u32 v19, v20, 1, v19
    v_and_b32 v20, 8, v17
    v_lshrrev_b32 v20, 1, v20
    v_add_u32 v19, v19, v20
    v_mul_u32_u24 v19, 3456, v19
    v_lshl_add_u32 v19, v18, 4, v19
    v_add_u32 v4, s63, v19
    v_add_u32 v24, 256, v24
    v_mul_u32_u24 v17, 2341, v24
    v_lshrrev_b32 v17, 16, v17
    v_mul_u32_u24 v18, 28, v17
    v_sub_u32 v18, v24, v18
    v_lshrrev_b32 v19, 1, v17
    v_and_b32 v19, 2, v19
    v_xor_b32 v18, v18, v19
    v_and_b32 v19, 0x33, v17
    v_and_b32 v20, 4, v17
    v_lshl_add_u32 v19, v20, 1, v19
    v_and_b32 v20, 8, v17
    v_lshrrev_b32 v20, 1, v20
    v_add_u32 v19, v19, v20
    v_mul_u32_u24 v19, 3456, v19
    v_lshl_add_u32 v19, v18, 4, v19
    v_add_u32 v5, s63, v19
    v_add_u32 v24, 256, v24
    v_mul_u32_u24 v17, 2341, v24
    v_lshrrev_b32 v17, 16, v17
    v_mul_u32_u24 v18, 28, v17
    v_sub_u32 v18, v24, v18
    v_lshrrev_b32 v19, 1, v17
    v_and_b32 v19, 2, v19
    v_xor_b32 v18, v18, v19
    v_and_b32 v19, 0x33, v17
    v_and_b32 v20, 4, v17
    v_lshl_add_u32 v19, v20, 1, v19
    v_and_b32 v20, 8, v17
    v_lshrrev_b32 v20, 1, v20
    v_add_u32 v19, v19, v20
    v_mul_u32_u24 v19, 3456, v19
    v_lshl_add_u32 v19, v18, 4, v19
    v_add_u32 v6, s63, v19
    v_add_u32 v24, 256, v24
    v_mul_u32_u24 v17, 2341, v24
    v_lshrrev_b32 v17, 16, v17
    v_mul_u32_u24 v18, 28, v17
    v_sub_u32 v18, v24, v18
    v_lshrrev_b32 v19, 1, v17
    v_and_b32 v19, 2, v19
    v_xor_b32 v18, v18, v19
    v_and_b32 v19, 0x33, v17
    v_and_b32 v20, 4, v17
    v_lshl_add_u32 v19, v20, 1, v19
    v_and_b32 v20, 8, v17
    v_lshrrev_b32 v20, 1, v20
    v_add_u32 v19, v19, v20
    v_mul_u32_u24 v19, 3456, v19
    v_lshl_add_u32 v19, v18, 4, v19
    v_add_u32 v7, s63, v19
    v_add_u32 v24, 256, v24
    v_mul_u32_u24 v17, 2341, v24
    v_lshrrev_b32 v17, 16, v17
    v_mul_u32_u24 v18, 28, v17
    v_sub_u32 v18, v24, v18
    v_lshrrev_b32 v19, 1, v17
    v_and_b32 v19, 2, v19
    v_xor_b32 v18, v18, v19
    v_and_b32 v19, 0x33, v17
    v_and_b32 v20, 4, v17
    v_lshl_add_u32 v19, v20, 1, v19
    v_and_b32 v20, 8, v17
    v_lshrrev_b32 v20, 1, v20
    v_add_u32 v19, v19, v20
    v_mul_u32_u24 v19, 3456, v19
    v_lshl_add_u32 v19, v18, 4, v19
    v_add_u32 v8, s63, v19
    v_add_u32 v24, 256, v24
    v_mul_u32_u24 v17, 2341, v24
    v_lshrrev_b32 v17, 16, v17
    v_mul_u32_u24 v18, 28, v17
    v_sub_u32 v18, v24, v18
    v_lshrrev_b32 v19, 1, v17
    v_and_b32 v19, 2, v19
    v_xor_b32 v18, v18, v19
    v_and_b32 v19, 0x33, v17
    v_and_b32 v20, 4, v17
    v_lshl_add_u32 v19, v20, 1, v19
    v_and_b32 v20, 8, v17
    v_lshrrev_b32 v20, 1, v20
    v_add_u32 v19, v19, v20
    v_mul_u32_u24 v19, 3456, v19
    v_lshl_add_u32 v19, v18, 4, v19
    v_add_u32 v9, s63, v19
    v_add_u32 v24, 256, v24
    v_mul_u32_u24 v17, 2341, v24
    v_lshrrev_b32 v17, 16, v17
    v_mul_u32_u24 v18, 28, v17
    v_sub_u32 v18, v24, v18
    v_lshrrev_b32 v19, 1, v17
    v_and_b32 v19, 2, v19
    v_xor_b32 v18, v18, v19
    v_and_b32 v19, 0x33, v17
    v_and_b32 v20, 4, v17
    v_lshl_add_u32 v19, v20, 1, v19
    v_and_b32 v20, 8, v17
    v_lshrrev_b32 v20, 1, v20
    v_add_u32 v19, v19, v20
    v_mul_u32_u24 v19, 3456, v19
    v_lshl_add_u32 v19, v18, 4, v19
    v_add_u32 v10, s63, v19
    s_lshl_b32 s61, s51, 7
    s_lshl_b32 s62, s50, 3
    s_add_u32 s61, s61, s62
    s_mul_i32 s61, s61, 1280
    s_and_b32 s15, s50, 1
    s_lshl_b32 s15, s15, 2
    v_lshrrev_b32 v16, 4, v1
    v_add_u32 v16, s15, v16
    v_xor_b32 v16, v16, v1
    v_and_b32 v16, 7, v16
    v_lshrrev_b32 v17, 3, v1
    v_mul_u32_u24 v17, 1280, v17
    v_lshl_add_u32 v17, v16, 4, v17
    v_add_u32 v12, s61, v17
    v_add_u32 v13, 40960, v12
    v_add_u32 v14, 81920, v12
    v_add_u32 v15, 122880, v12
    s_mov_b32 s58, s63
    s_waitcnt lgkmcnt(0)
    s_mov_b32 s16, s68
    s_and_b32 s17, s69, 0xffff
    s_mov_b32 s18, 2621440
    s_mov_b32 s19, 0x20000
    s_mov_b32 s20, s76
    s_and_b32 s21, s77, 0xffff
    s_mov_b32 s22, 2211840
    s_mov_b32 s23, 0x20000
    s_mov_b32 s64, 2621440
    s_mov_b32 s65, 2211840
    s_lshl_b32 s67, s50, 10
    s_mov_b32 s53, 0
    s_mov_b32 s60, 0
    s_and_b32 s14, s51, 1
    s_mov_b32 s40, s84
    s_and_b32 s41, s85, 0xffff
    s_mov_b32 s42, 1280
    s_mov_b32 s43, 0x20000
    s_mov_b32 s44, s86
    s_and_b32 s45, s87, 0xffff
    s_mov_b32 s46, 2621440
    s_mov_b32 s47, 0x20000
    s_xor_b32 s61, s14, 0
    s_mul_i32 s55, s61, 221184
    s_lshl_b32 s56, s61, 7
    s_mov_b32 s54, s67
    s_add_u32 m0, s54, 0
    s_nop 0
    buffer_load_dwordx4 v4, s[20:23], s55 offen lds
    s_add_u32 m0, s54, 4096
    s_nop 0
    buffer_load_dwordx4 v5, s[20:23], s55 offen lds
    s_add_u32 m0, s54, 28672
    s_nop 0
    buffer_load_dwordx4 v12, s[16:19], s56 offen lds
    s_add_u32 m0, s54, 8192
    s_nop 0
    buffer_load_dwordx4 v6, s[20:23], s55 offen lds
    s_add_u32 m0, s54, 32768
    s_nop 0
    buffer_load_dwordx4 v13, s[16:19], s56 offen lds
    s_add_u32 m0, s54, 12288
    s_nop 0
    buffer_load_dwordx4 v7, s[20:23], s55 offen lds
    s_add_u32 m0, s54, 16384
    s_nop 0
    buffer_load_dwordx4 v8, s[20:23], s55 offen lds
    s_add_u32 m0, s54, 36864
    s_nop 0
    buffer_load_dwordx4 v14, s[16:19], s56 offen lds
    s_add_u32 m0, s54, 20480
    s_nop 0
    buffer_load_dwordx4 v9, s[20:23], s55 offen lds
    s_add_u32 m0, s54, 40960
    s_nop 0
    buffer_load_dwordx4 v15, s[16:19], s56 offen lds
    s_add_u32 m0, s54, 24576
    s_nop 0
    buffer_load_dwordx4 v10, s[20:23], s55 offen lds
    s_xor_b32 s61, s14, 1
    s_mul_i32 s55, s61, 221184
    s_lshl_b32 s56, s61, 7
    s_add_u32 s54, s67, 45056
    s_add_u32 m0, s54, 0
    s_nop 0
    buffer_load_dwordx4 v4, s[20:23], s55 offen lds
    s_add_u32 m0, s54, 4096
    s_nop 0
    buffer_load_dwordx4 v5, s[20:23], s55 offen lds
    s_add_u32 m0, s54, 28672
    s_nop 0
    buffer_load_dwordx4 v12, s[16:19], s56 offen lds
    s_add_u32 m0, s54, 8192
    s_nop 0
    buffer_load_dwordx4 v6, s[20:23], s55 offen lds
    s_add_u32 m0, s54, 32768
    s_nop 0
    buffer_load_dwordx4 v13, s[16:19], s56 offen lds
    s_add_u32 m0, s54, 12288
    s_nop 0
    buffer_load_dwordx4 v7, s[20:23], s55 offen lds
    s_add_u32 m0, s54, 16384
    s_nop 0
    buffer_load_dwordx4 v8, s[20:23], s55 offen lds
    s_add_u32 m0, s54, 36864
    s_nop 0
    buffer_load_dwordx4 v14, s[16:19], s56 offen lds
    s_add_u32 m0, s54, 20480
    s_nop 0
    buffer_load_dwordx4 v9, s[20:23], s55 offen lds
    s_add_u32 m0, s54, 40960
    s_nop 0
    buffer_load_dwordx4 v15, s[16:19], s56 offen lds
    s_add_u32 m0, s54, 24576
    s_nop 0
    buffer_load_dwordx4 v10, s[20:23], s55 offen lds
    s_lshl_b32 s61, s51, 3
    s_add_u32 s61, s61, s52
    s_mul_i32 s92, s61, 3
    s_add_u32 s92, s92, s50
    s_cmp_eq_u32 s50, 3
    s_cselect_b32 s92, 999, s92
    s_mul_hi_u32 s93, s92, 858993460
    s_mul_i32 s61, s93, 5
    s_sub_u32 s94, s92, s61
    s_cmp_lt_u32 s93, 54
    s_cselect_b32 s24, s80, s72
    s_cselect_b32 s25, s81, s73
    s_cselect_b32 s61, 0, 54
    s_mov_b32 s62, 819200
    s_cselect_b32 s26, 2211840, s62
    s_and_b32 s25, s25, 0xffff
    s_mov_b32 s27, 0x20000
    s_sub_u32 s61, s93, s61
    s_lshl_b32 s62, s61, 5
    s_lshr_b32 s63, s61, 1
    s_mul_i32 s63, s63, 80
    s_and_b32 s15, s61, 1
    s_lshl_b32 s15, s15, 5
    s_add_u32 s63, s63, s15
    s_mul_i32 s15, s61, 160
    s_sub_u32 s15, s15, 2496
    s_cmp_ge_u32 s61, 16
    s_cselect_b32 s63, s15, s63
    s_cselect_b32 s75, 80, 16
    s_cmp_lt_u32 s93, 54
    s_cselect_b32 s61, s62, s63
    s_cselect_b32 s75, 16, s75
    s_mul_i32 s75, s75, 1280
    s_mul_i32 s61, s61, 1280
    s_lshl_b32 s62, s94, 8
    s_add_u32 s63, s61, s62
    s_mov_b32 s74, s63
    v_lshrrev_b32 v2, 4, v1
    v_lshlrev_b32 v220, 1, v2
    v_xor_b32 v220, v220, v1
    v_and_b32 v220, 15, v220
    v_xor_b32 v221, 8, v220
    v_mul_u32_u24 v2, 1280, v2
    v_add_u32 v2, s63, v2
    v_lshl_add_u32 v220, v220, 4, v2
    v_lshl_add_u32 v221, v221, 4, v2
    s_cmp_ge_u32 s92, 370
    s_cbranch_scc1 L_rp_noissue
    s_lshl_b32 s62, s50, 13
    s_add_u32 s62, s62, 135168
    s_add_u32 m0, s62, 0
    s_mov_b32 s15, 0
    buffer_load_dwordx4 v220, s[24:27], s15 offen lds
    s_add_u32 m0, s62, 1024
    s_mov_b32 s15, 5120
    buffer_load_dwordx4 v221, s[24:27], s15 offen lds
    s_add_u32 m0, s62, 2048
    s_mov_b32 s15, 10240
    buffer_load_dwordx4 v220, s[24:27], s15 offen lds
    s_add_u32 m0, s62, 3072
    s_mov_b32 s15, 15360
    buffer_load_dwordx4 v221, s[24:27], s15 offen lds
    s_add_u32 m0, s62, 4096
    s_add_u32 s15, s75, 0
    buffer_load_dwordx4 v220, s[24:27], s15 offen lds
    s_add_u32 m0, s62, 5120
    s_add_u32 s15, s75, 5120
    buffer_load_dwordx4 v221, s[24:27], s15 offen lds
    s_add_u32 m0, s62, 6144
    s_add_u32 s15, s75, 10240
    buffer_load_dwordx4 v220, s[24:27], s15 offen lds
    s_add_u32 m0, s62, 7168
    s_add_u32 s15, s75, 15360
    buffer_load_dwordx4 v221, s[24:27], s15 offen lds
L_rp_noissue:
    s_xor_b32 s61, s14, 2
    s_mul_i32 s55, s61, 221184
    s_lshl_b32 s56, s61, 7
    s_add_u32 s54, s67, 90112
    s_lshl_b32 s63, s51, 3
    s_add_u32 s63, s63, s52
    s_mul_i32 s61, s63, 12288
    s_lshl_b32 s62, s50, 10
    s_add_u32 s61, s61, s62
    s_add_u32 s61, s61, 663552
    v_lshlrev_b32 v212, 4, v1
    v_add_u32 v212, s61, v212
    s_mul_i32 s61, s63, 20480
    s_lshl_b32 s62, s50, 10
    s_add_u32 s61, s61, s62
    v_lshlrev_b32 v213, 4, v1
    v_add_u32 v213, s61, v213
    s_mov_b32 s36, s78
    s_and_b32 s37, s79, 0xffff
    s_mov_b32 s38, 3456
    s_mov_b32 s39, 0x20000
    s_cmp_lg_u32 s50, 3
    s_cbranch_scc1 L_side_skip
    v_lshlrev_b32 v216, 4, v1
    s_mov_b32 m0, 159744
    v_add_u32 v217, 1024, v216
    buffer_load_dwordx4 v216, s[40:43], 0 offen lds
    s_mov_b32 m0, 160768
    v_add_u32 v218, s58, v216
    buffer_load_dwordx4 v217, s[40:43], 0 offen lds
    s_mov_b32 m0, 161792
    s_nop 0
    buffer_load_dwordx4 v218, s[36:39], 0 offen lds
L_side_skip:
    s_mov_b32 s28, s90
    s_and_b32 s29, s91, 0xffff
    s_mov_b32 s30, 9699328
    s_mov_b32 s31, 0x20000
    s_add_u32 s32, s90, 9830400
    s_addc_u32 s33, s91, 0
    s_and_b32 s33, s33, 0xffff
    s_mov_b32 s34, 3031040
    s_mov_b32 s35, 0x20000
    s_mov_b64 s[48:49], s[88:89]
    v_lshrrev_b32 v216, 2, v1
    v_and_b32 v217, 7, v216
    v_lshlrev_b32 v217, 5, v217
    v_lshl_add_u32 v216, v216, 8, v217
    v_and_b32 v217, 3, v1
    v_lshl_add_u32 v216, v217, 3, v216
    s_lshl_b32 s62, s50, 13
    s_add_u32 s62, s62, 135168
    v_add_u32 v216, s62, v216
    v_lshlrev_b32 v219, 4, v1
    s_mul_i32 s91, s93, 40
    s_lshl_b32 s61, s94, 3
    s_add_u32 s91, s91, s61
    s_lshl_b32 s91, s91, 10
    v_mov_b32 v217, v216
    s_cmp_lt_u32 s92, 370
    s_cselect_b64 vcc, -1, 0
    v_cndmask_b32 v218, -1, v219, vcc
    v_mov_b32 v219, -1
    s_mov_b32 s90, 0
    s_sub_u32 s91, s91, 2048
    v_add_u32 v244, s53, v240
    v_add_u32 v246, s53, v242
    v_add_u32 v247, s53, v243
    v_add_u32 v245, s53, v241
    s_cmp_lt_u32 s92, 370
    s_cbranch_scc1 L_h_w0_rp
    s_waitcnt vmcnt(11)
    s_branch L_h_w0_done
L_h_w0_rp:
    s_waitcnt vmcnt(19)
L_h_w0_done:
    s_barrier
    ds_read_b64_tr_b16 v[224:225], v217
    ds_read_b64_tr_b16 v[226:227], v217 offset:4096
    ds_read_b64_tr_b16 a[40:41], v246 offset:0
    ds_read_b64_tr_b16 a[42:43], v246 offset:3584
    ds_read_b128 a[0:3], v244 offset:0
    ds_read_b128 a[4:7], v244 offset:2048
    ds_read_b128 a[8:11], v244 offset:4096
    ds_read_b128 a[12:15], v244 offset:6144
    ds_read_b64_tr_b16 a[44:45], v247 offset:32
    ds_read_b64_tr_b16 a[46:47], v247 offset:3616
    ds_read_b64_tr_b16 a[48:49], v246 offset:64
    ds_read_b64_tr_b16 a[50:51], v246 offset:3648
    ds_read_b64_tr_b16 a[52:53], v247 offset:96
    ds_read_b64_tr_b16 a[54:55], v247 offset:3680
    ds_read_b64_tr_b16 a[56:57], v246 offset:128
    ds_read_b64_tr_b16 a[58:59], v246 offset:3712
    ds_read_b64_tr_b16 a[60:61], v247 offset:160
    ds_read_b64_tr_b16 a[62:63], v247 offset:3744
    ds_read_b64_tr_b16 a[64:65], v246 offset:192
    ds_read_b64_tr_b16 a[66:67], v246 offset:3776
    s_waitcnt lgkmcnt(12)
    v_mfma_f32_16x16x32_bf16 v[16:19], a[40:43], a[0:3], 0
    s_add_u32 m0, s54, 0
    ds_read_b64_tr_b16 v[228:229], v217
    v_mfma_f32_16x16x32_bf16 v[44:47], a[40:43], a[4:7], 0
    buffer_load_dwordx4 v4, s[20:23], s55 offen lds
    s_add_u32 m0, s54, 4096
    v_mfma_f32_16x16x32_bf16 v[72:75], a[40:43], a[8:11], 0
    buffer_load_dwordx4 v5, s[20:23], s55 offen lds
    v_mfma_f32_16x16x32_bf16 v[100:103], a[40:43], a[12:15], 0
    s_add_u32 m0, s54, 28672
    ds_read_b64_tr_b16 v[230:231], v217 offset:4096
    s_waitcnt lgkmcnt(12)
    v_mfma_f32_16x16x32_bf16 v[20:23], a[44:47], a[0:3], 0
    buffer_load_dwordx4 v12, s[16:19], s56 offen lds
    s_add_u32 m0, s54, 8192
    v_mfma_f32_16x16x32_bf16 v[48:51], a[44:47], a[4:7], 0
    buffer_load_dwordx4 v6, s[20:23], s55 offen lds
    s_add_u32 m0, s54, 32768
    v_mfma_f32_16x16x32_bf16 v[76:79], a[44:47], a[8:11], 0
    buffer_load_dwordx4 v13, s[16:19], s56 offen lds
    s_add_u32 m0, s54, 12288
    v_mfma_f32_16x16x32_bf16 v[104:107], a[44:47], a[12:15], 0
    buffer_load_dwordx4 v7, s[20:23], s55 offen lds
    s_waitcnt lgkmcnt(10)
    v_mfma_f32_16x16x32_bf16 v[24:27], a[48:51], a[0:3], 0
    ds_read_b64_tr_b16 a[72:73], v246 offset:14336
    v_mfma_f32_16x16x32_bf16 v[52:55], a[48:51], a[4:7], 0
    buffer_load_dwordx4 v[208:211], v212, s[20:23], 0 offen
    v_add_u32 v212, 4096, v212
    v_mfma_f32_16x16x32_bf16 v[80:83], a[48:51], a[8:11], 0
    buffer_load_dwordx4 v[208:211], v212, s[20:23], 0 offen
    v_add_u32 v212, 4096, v212
    v_mfma_f32_16x16x32_bf16 v[108:111], a[48:51], a[12:15], 0
    buffer_load_dwordx4 v[208:211], v212, s[20:23], 0 offen
    s_waitcnt lgkmcnt(9)
    v_mfma_f32_16x16x32_bf16 v[28:31], a[52:55], a[0:3], 0
    buffer_load_dwordx4 v[208:211], v213, s[16:19], 0 offen
    v_mfma_f32_16x16x32_bf16 v[56:59], a[52:55], a[4:7], 0
    v_add_u32 v213, 4096, v213
    ds_read_b64_tr_b16 a[74:75], v246 offset:17920
    v_mfma_f32_16x16x32_bf16 v[84:87], a[52:55], a[8:11], 0
    buffer_load_dwordx4 v[208:211], v213, s[16:19], 0 offen
    v_add_u32 v213, 4096, v213
    v_mfma_f32_16x16x32_bf16 v[112:115], a[52:55], a[12:15], 0
    buffer_load_dwordx4 v[208:211], v213, s[16:19], 0 offen
    v_add_u32 v213, 4096, v213
    s_waitcnt lgkmcnt(8)
    v_mfma_f32_16x16x32_bf16 v[32:35], a[56:59], a[0:3], 0
    buffer_load_dwordx4 v[208:211], v213, s[16:19], 0 offen
    v_add_u32 v213, 4096, v213
    v_mfma_f32_16x16x32_bf16 v[60:63], a[56:59], a[4:7], 0
    buffer_load_dwordx4 v[208:211], v213, s[16:19], 0 offen
    v_mfma_f32_16x16x32_bf16 v[88:91], a[56:59], a[8:11], 0
    s_add_u32 m0, s54, 16384
    ds_read_b128 a[20:23], v245 offset:0
    v_mfma_f32_16x16x32_bf16 v[116:119], a[56:59], a[12:15], 0
    buffer_load_dwordx4 v8, s[20:23], s55 offen lds
    s_add_u32 m0, s54, 36864
    s_waitcnt lgkmcnt(7)
    v_mfma_f32_16x16x32_bf16 v[36:39], a[60:63], a[0:3], 0
    buffer_load_dwordx4 v14, s[16:19], s56 offen lds
    s_add_u32 m0, s54, 20480
    v_mfma_f32_16x16x32_bf16 v[64:67], a[60:63], a[4:7], 0
    buffer_load_dwordx4 v9, s[20:23], s55 offen lds
    s_add_u32 m0, s54, 40960
    v_mfma_f32_16x16x32_bf16 v[92:95], a[60:63], a[8:11], 0
    buffer_load_dwordx4 v15, s[16:19], s56 offen lds
    v_mfma_f32_16x16x32_bf16 v[120:123], a[60:63], a[12:15], 0
    s_add_u32 m0, s54, 24576
    ds_read_b128 a[24:27], v245 offset:2048
    s_waitcnt lgkmcnt(6)
    v_mfma_f32_16x16x32_bf16 v[40:43], a[64:67], a[0:3], 0
    buffer_load_dwordx4 v10, s[20:23], s55 offen lds
    v_mfma_f32_16x16x32_bf16 v[68:71], a[64:67], a[4:7], 0
    buffer_store_dwordx4 v[224:227], v219, s[32:35], s91 offen sc1
    v_mfma_f32_16x16x32_bf16 v[96:99], a[64:67], a[8:11], 0
    ds_read_b128 a[28:31], v245 offset:4096
    v_mfma_f32_16x16x32_bf16 v[124:127], a[64:67], a[12:15], 0
    ds_read_b128 a[32:35], v245 offset:6144
    ds_read_b64_tr_b16 a[76:77], v247 offset:14368
    ds_read_b64_tr_b16 a[78:79], v247 offset:17952
    ds_read_b64_tr_b16 a[80:81], v246 offset:14400
    ds_read_b64_tr_b16 a[82:83], v246 offset:17984
    ds_read_b64_tr_b16 a[84:85], v247 offset:14432
    ds_read_b64_tr_b16 a[86:87], v247 offset:18016
    ds_read_b64_tr_b16 a[88:89], v246 offset:14464
    ds_read_b64_tr_b16 a[90:91], v246 offset:18048
    ds_read_b64_tr_b16 a[92:93], v247 offset:14496
    ds_read_b64_tr_b16 a[94:95], v247 offset:18080
    ds_read_b64_tr_b16 a[96:97], v246 offset:14528
    ds_read_b64_tr_b16 a[98:99], v246 offset:18112
    s_max_i32 s15, s90, 0
    v_xor_b32 v217, s15, v216
    s_add_u32 s90, s90, 32
    s_add_u32 s91, s91, 1024
    s_add_u32 s54, s53, s67
    s_add_u32 s61, s60, 3
    s_xor_b32 s61, s61, s14
    s_waitcnt lgkmcnt(15)
    s_branch L_h_loop1_B
L_h_loop1:
    s_waitcnt lgkmcnt(12)
    v_mfma_f32_16x16x32_bf16 v[16:19], a[40:43], a[0:3], v[16:19]
    ds_read_b64_tr_b16 v[228:229], v217
    v_mfma_f32_16x16x32_bf16 v[44:47], a[40:43], a[4:7], v[44:47]
    s_add_u32 m0, s54, 16384
    ds_read_b64_tr_b16 v[230:231], v217 offset:4096
    v_mfma_f32_16x16x32_bf16 v[72:75], a[40:43], a[8:11], v[72:75]
    buffer_load_dwordx4 v8, s[20:23], s55 offen lds
    v_mfma_f32_16x16x32_bf16 v[100:103], a[40:43], a[12:15], v[100:103]
    ds_read_b64_tr_b16 a[72:73], v246 offset:14336
    s_waitcnt lgkmcnt(13)
    v_mfma_f32_16x16x32_bf16 v[20:23], a[44:47], a[0:3], v[20:23]
    s_add_u32 m0, s54, 36864
    ds_read_b64_tr_b16 a[74:75], v246 offset:17920
    v_mfma_f32_16x16x32_bf16 v[48:51], a[44:47], a[4:7], v[48:51]
    buffer_load_dwordx4 v14, s[16:19], s56 offen lds
    v_mfma_f32_16x16x32_bf16 v[76:79], a[44:47], a[8:11], v[76:79]
    ds_read_b128 a[20:23], v245 offset:0
    v_mfma_f32_16x16x32_bf16 v[104:107], a[44:47], a[12:15], v[104:107]
    s_add_u32 m0, s54, 20480
    ds_read_b128 a[24:27], v245 offset:2048
    s_waitcnt lgkmcnt(14)
    v_mfma_f32_16x16x32_bf16 v[24:27], a[48:51], a[0:3], v[24:27]
    buffer_load_dwordx4 v9, s[20:23], s55 offen lds
    v_mfma_f32_16x16x32_bf16 v[52:55], a[48:51], a[4:7], v[52:55]
    s_add_u32 m0, s54, 40960
    ds_read_b128 a[28:31], v245 offset:4096
    v_mfma_f32_16x16x32_bf16 v[80:83], a[48:51], a[8:11], v[80:83]
    buffer_load_dwordx4 v15, s[16:19], s56 offen lds
    v_mfma_f32_16x16x32_bf16 v[108:111], a[48:51], a[12:15], v[108:111]
    ds_read_b128 a[32:35], v245 offset:6144
    s_waitcnt lgkmcnt(14)
    v_mfma_f32_16x16x32_bf16 v[28:31], a[52:55], a[0:3], v[28:31]
    s_add_u32 m0, s54, 24576
    ds_read_b64_tr_b16 a[76:77], v247 offset:14368
    v_mfma_f32_16x16x32_bf16 v[56:59], a[52:55], a[4:7], v[56:59]
    buffer_load_dwordx4 v10, s[20:23], s55 offen lds
    v_mfma_f32_16x16x32_bf16 v[84:87], a[52:55], a[8:11], v[84:87]
    ds_read_b64_tr_b16 a[78:79], v247 offset:17952
    v_mfma_f32_16x16x32_bf16 v[112:115], a[52:55], a[12:15], v[112:115]
    ds_read_b64_tr_b16 a[80:81], v246 offset:14400
    s_waitcnt lgkmcnt(15)
    v_mfma_f32_16x16x32_bf16 v[32:35], a[56:59], a[0:3], v[32:35]
    buffer_store_dwordx4 v[224:227], v219, s[32:35], s91 offen sc1
    v_mfma_f32_16x16x32_bf16 v[60:63], a[56:59], a[4:7], v[60:63]
    ds_read_b64_tr_b16 a[82:83], v246 offset:17984
    v_mfma_f32_16x16x32_bf16 v[88:91], a[56:59], a[8:11], v[88:91]
    ds_read_b64_tr_b16 a[84:85], v247 offset:14432
    v_mfma_f32_16x16x32_bf16 v[116:119], a[56:59], a[12:15], v[116:119]
    ds_read_b64_tr_b16 a[86:87], v247 offset:18016
    s_waitcnt lgkmcnt(15)
    v_mfma_f32_16x16x32_bf16 v[36:39], a[60:63], a[0:3], v[36:39]
    ds_read_b64_tr_b16 a[88:89], v246 offset:14464
    v_mfma_f32_16x16x32_bf16 v[64:67], a[60:63], a[4:7], v[64:67]
    ds_read_b64_tr_b16 a[90:91], v246 offset:18048
    v_mfma_f32_16x16x32_bf16 v[92:95], a[60:63], a[8:11], v[92:95]
    ds_read_b64_tr_b16 a[92:93], v247 offset:14496
    v_mfma_f32_16x16x32_bf16 v[120:123], a[60:63], a[12:15], v[120:123]
    ds_read_b64_tr_b16 a[94:95], v247 offset:18080
    s_waitcnt lgkmcnt(15)
    v_mfma_f32_16x16x32_bf16 v[40:43], a[64:67], a[0:3], v[40:43]
    ds_read_b64_tr_b16 a[96:97], v246 offset:14528
    v_mfma_f32_16x16x32_bf16 v[68:71], a[64:67], a[4:7], v[68:71]
    ds_read_b64_tr_b16 a[98:99], v246 offset:18112
    s_max_i32 s15, s90, 0
    v_mfma_f32_16x16x32_bf16 v[96:99], a[64:67], a[8:11], v[96:99]
    v_xor_b32 v217, s15, v216
    s_add_u32 s90, s90, 32
    s_add_u32 s91, s91, 1024
    v_mfma_f32_16x16x32_bf16 v[124:127], a[64:67], a[12:15], v[124:127]
    s_add_u32 s54, s53, s67
    s_add_u32 s61, s60, 3
    s_xor_b32 s61, s61, s14
L_h_loop1_B:
    s_waitcnt lgkmcnt(12)
    v_mfma_f32_16x16x32_bf16 v[16:19], a[72:75], a[20:23], v[16:19]
    s_mul_i32 s55, s61, 221184
    s_lshl_b32 s56, s61, 7
    s_add_u32 s53, s53, 45056
    v_mfma_f32_16x16x32_bf16 v[44:47], a[72:75], a[24:27], v[44:47]
    s_cmp_eq_u32 s53, 135168
    s_cselect_b32 s53, 0, s53
    v_add_u32 v244, s53, v240
    v_mfma_f32_16x16x32_bf16 v[72:75], a[72:75], a[28:31], v[72:75]
    v_add_u32 v246, s53, v242
    v_mfma_f32_16x16x32_bf16 v[100:103], a[72:75], a[32:35], v[100:103]
    v_add_u32 v247, s53, v243
    v_add_u32 v245, s53, v241
    s_cmp_eq_u32 s60, 0
    s_cbranch_scc1 L_h_alt0
    s_waitcnt vmcnt(14) lgkmcnt(0)
L_h_alt0_ret:
    s_barrier
    v_mfma_f32_16x16x32_bf16 v[20:23], a[76:79], a[20:23], v[20:23]
    ds_read_b64_tr_b16 v[224:225], v217
    v_mfma_f32_16x16x32_bf16 v[48:51], a[76:79], a[24:27], v[48:51]
    s_add_u32 m0, s54, 0
    ds_read_b64_tr_b16 v[226:227], v217 offset:4096
    v_mfma_f32_16x16x32_bf16 v[76:79], a[76:79], a[28:31], v[76:79]
    buffer_load_dwordx4 v4, s[20:23], s55 offen lds
    v_mfma_f32_16x16x32_bf16 v[104:107], a[76:79], a[32:35], v[104:107]
    ds_read_b64_tr_b16 a[40:41], v246 offset:0
    v_mfma_f32_16x16x32_bf16 v[24:27], a[80:83], a[20:23], v[24:27]
    s_add_u32 m0, s54, 4096
    ds_read_b64_tr_b16 a[42:43], v246 offset:3584
    v_mfma_f32_16x16x32_bf16 v[52:55], a[80:83], a[24:27], v[52:55]
    buffer_load_dwordx4 v5, s[20:23], s55 offen lds
    v_mfma_f32_16x16x32_bf16 v[80:83], a[80:83], a[28:31], v[80:83]
    ds_read_b128 a[0:3], v244 offset:0
    v_mfma_f32_16x16x32_bf16 v[108:111], a[80:83], a[32:35], v[108:111]
    s_add_u32 m0, s54, 28672
    ds_read_b128 a[4:7], v244 offset:2048
    v_mfma_f32_16x16x32_bf16 v[28:31], a[84:87], a[20:23], v[28:31]
    buffer_load_dwordx4 v12, s[16:19], s56 offen lds
    v_mfma_f32_16x16x32_bf16 v[56:59], a[84:87], a[24:27], v[56:59]
    ds_read_b128 a[8:11], v244 offset:4096
    v_mfma_f32_16x16x32_bf16 v[84:87], a[84:87], a[28:31], v[84:87]
    s_add_u32 m0, s54, 8192
    ds_read_b128 a[12:15], v244 offset:6144
    v_mfma_f32_16x16x32_bf16 v[112:115], a[84:87], a[32:35], v[112:115]
    buffer_load_dwordx4 v6, s[20:23], s55 offen lds
    v_mfma_f32_16x16x32_bf16 v[32:35], a[88:91], a[20:23], v[32:35]
    ds_read_b64_tr_b16 a[44:45], v247 offset:32
    v_mfma_f32_16x16x32_bf16 v[60:63], a[88:91], a[24:27], v[60:63]
    s_add_u32 m0, s54, 32768
    ds_read_b64_tr_b16 a[46:47], v247 offset:3616
    v_mfma_f32_16x16x32_bf16 v[88:91], a[88:91], a[28:31], v[88:91]
    buffer_load_dwordx4 v13, s[16:19], s56 offen lds
    v_mfma_f32_16x16x32_bf16 v[116:119], a[88:91], a[32:35], v[116:119]
    ds_read_b64_tr_b16 a[48:49], v246 offset:64
    v_mfma_f32_16x16x32_bf16 v[36:39], a[92:95], a[20:23], v[36:39]
    s_add_u32 m0, s54, 12288
    ds_read_b64_tr_b16 a[50:51], v246 offset:3648
    v_mfma_f32_16x16x32_bf16 v[64:67], a[92:95], a[24:27], v[64:67]
    buffer_load_dwordx4 v7, s[20:23], s55 offen lds
    v_mfma_f32_16x16x32_bf16 v[92:95], a[92:95], a[28:31], v[92:95]
    ds_read_b64_tr_b16 a[52:53], v247 offset:96
    v_mfma_f32_16x16x32_bf16 v[120:123], a[92:95], a[32:35], v[120:123]
    ds_read_b64_tr_b16 a[54:55], v247 offset:3680
    v_mfma_f32_16x16x32_bf16 v[40:43], a[96:99], a[20:23], v[40:43]
    buffer_store_dwordx4 v[228:231], v219, s[32:35], s91 offen sc1
    v_mfma_f32_16x16x32_bf16 v[68:71], a[96:99], a[24:27], v[68:71]
    ds_read_b64_tr_b16 a[56:57], v246 offset:128
    v_mfma_f32_16x16x32_bf16 v[96:99], a[96:99], a[28:31], v[96:99]
    ds_read_b64_tr_b16 a[58:59], v246 offset:3712
    v_mfma_f32_16x16x32_bf16 v[124:127], a[96:99], a[32:35], v[124:127]
    ds_read_b64_tr_b16 a[60:61], v247 offset:160
    ds_read_b64_tr_b16 a[62:63], v247 offset:3744
    ds_read_b64_tr_b16 a[64:65], v246 offset:192
    ds_read_b64_tr_b16 a[66:67], v246 offset:3776
    s_max_i32 s15, s90, 0
    v_xor_b32 v217, s15, v216
    s_add_u32 s90, s90, 32
    s_add_u32 s91, s91, 1024
    v_mov_b32 v219, v218
    s_add_u32 s60, s60, 1
    s_cmp_lt_u32 s60, 5
    s_cbranch_scc1 L_h_loop1
L_h_loop:
    s_waitcnt lgkmcnt(12)
    v_mfma_f32_16x16x32_bf16 v[16:19], a[40:43], a[0:3], v[16:19]
    ds_read_b64_tr_b16 a[72:73], v246 offset:14336
    v_mfma_f32_16x16x32_bf16 v[44:47], a[40:43], a[4:7], v[44:47]
    s_add_u32 m0, s54, 16384
    ds_read_b64_tr_b16 a[74:75], v246 offset:17920
    v_mfma_f32_16x16x32_bf16 v[72:75], a[40:43], a[8:11], v[72:75]
    buffer_load_dwordx4 v8, s[20:23], s55 offen lds
    v_mfma_f32_16x16x32_bf16 v[100:103], a[40:43], a[12:15], v[100:103]
    ds_read_b128 a[20:23], v245 offset:0
    s_waitcnt lgkmcnt(13)
    v_mfma_f32_16x16x32_bf16 v[20:23], a[44:47], a[0:3], v[20:23]
    ds_read_b128 a[24:27], v245 offset:2048
    v_mfma_f32_16x16x32_bf16 v[48:51], a[44:47], a[4:7], v[48:51]
    s_add_u32 m0, s54, 36864
    ds_read_b128 a[28:31], v245 offset:4096
    v_mfma_f32_16x16x32_bf16 v[76:79], a[44:47], a[8:11], v[76:79]
    buffer_load_dwordx4 v14, s[16:19], s56 offen lds
    v_mfma_f32_16x16x32_bf16 v[104:107], a[44:47], a[12:15], v[104:107]
    ds_read_b128 a[32:35], v245 offset:6144
    s_waitcnt lgkmcnt(14)
    v_mfma_f32_16x16x32_bf16 v[24:27], a[48:51], a[0:3], v[24:27]
    s_add_u32 m0, s54, 20480
    ds_read_b64_tr_b16 a[76:77], v247 offset:14368
    v_mfma_f32_16x16x32_bf16 v[52:55], a[48:51], a[4:7], v[52:55]
    buffer_load_dwordx4 v9, s[20:23], s55 offen lds
    v_mfma_f32_16x16x32_bf16 v[80:83], a[48:51], a[8:11], v[80:83]
    ds_read_b64_tr_b16 a[78:79], v247 offset:17952
    v_mfma_f32_16x16x32_bf16 v[108:111], a[48:51], a[12:15], v[108:111]
    s_add_u32 m0, s54, 40960
    ds_read_b64_tr_b16 a[80:81], v246 offset:14400
    s_waitcnt lgkmcnt(15)
    v_mfma_f32_16x16x32_bf16 v[28:31], a[52:55], a[0:3], v[28:31]
    buffer_load_dwordx4 v15, s[16:19], s56 offen lds
    v_mfma_f32_16x16x32_bf16 v[56:59], a[52:55], a[4:7], v[56:59]
    ds_read_b64_tr_b16 a[82:83], v246 offset:17984
    v_mfma_f32_16x16x32_bf16 v[84:87], a[52:55], a[8:11], v[84:87]
    ds_read_b64_tr_b16 a[84:85], v247 offset:14432
    v_mfma_f32_16x16x32_bf16 v[112:115], a[52:55], a[12:15], v[112:115]
    s_add_u32 m0, s54, 24576
    ds_read_b64_tr_b16 a[86:87], v247 offset:18016
    s_waitcnt lgkmcnt(15)
    v_mfma_f32_16x16x32_bf16 v[32:35], a[56:59], a[0:3], v[32:35]
    buffer_load_dwordx4 v10, s[20:23], s55 offen lds
    v_mfma_f32_16x16x32_bf16 v[60:63], a[56:59], a[4:7], v[60:63]
    ds_read_b64_tr_b16 a[88:89], v246 offset:14464
    v_mfma_f32_16x16x32_bf16 v[88:91], a[56:59], a[8:11], v[88:91]
    ds_read_b64_tr_b16 a[90:91], v246 offset:18048
    v_mfma_f32_16x16x32_bf16 v[116:119], a[56:59], a[12:15], v[116:119]
    ds_read_b64_tr_b16 a[92:93], v247 offset:14496
    s_waitcnt lgkmcnt(15)
    v_mfma_f32_16x16x32_bf16 v[36:39], a[60:63], a[0:3], v[36:39]
    ds_read_b64_tr_b16 a[94:95], v247 offset:18080
    v_mfma_f32_16x16x32_bf16 v[64:67], a[60:63], a[4:7], v[64:67]
    ds_read_b64_tr_b16 a[96:97], v246 offset:14528
    v_mfma_f32_16x16x32_bf16 v[92:95], a[60:63], a[8:11], v[92:95]
    ds_read_b64_tr_b16 a[98:99], v246 offset:18112
    s_add_u32 s54, s53, s67
    v_mfma_f32_16x16x32_bf16 v[120:123], a[60:63], a[12:15], v[120:123]
    s_add_u32 s61, s60, 3
    s_xor_b32 s61, s61, s14
    s_mul_i32 s55, s61, 221184
    v_mfma_f32_16x16x32_bf16 v[40:43], a[64:67], a[0:3], v[40:43]
    s_lshl_b32 s56, s61, 7
    s_cmp_lt_u32 s60, 7
    s_cselect_b32 s22, s65, 0
    v_mfma_f32_16x16x32_bf16 v[68:71], a[64:67], a[4:7], v[68:71]
    s_cselect_b32 s18, s64, 0
    s_add_u32 s53, s53, 45056
    s_cmp_eq_u32 s53, 135168
    v_mfma_f32_16x16x32_bf16 v[96:99], a[64:67], a[8:11], v[96:99]
    s_cselect_b32 s53, 0, s53
    v_add_u32 v244, s53, v240
    v_mfma_f32_16x16x32_bf16 v[124:127], a[64:67], a[12:15], v[124:127]
    v_add_u32 v246, s53, v242
    s_waitcnt lgkmcnt(12)
    v_mfma_f32_16x16x32_bf16 v[16:19], a[72:75], a[20:23], v[16:19]
    v_add_u32 v247, s53, v243
    v_mfma_f32_16x16x32_bf16 v[44:47], a[72:75], a[24:27], v[44:47]
    v_add_u32 v245, s53, v241
    v_mfma_f32_16x16x32_bf16 v[72:75], a[72:75], a[28:31], v[72:75]
    v_mfma_f32_16x16x32_bf16 v[100:103], a[72:75], a[32:35], v[100:103]
    s_waitcnt vmcnt(11) lgkmcnt(0)
    s_barrier
    s_cmp_eq_u32 s60, 6
    s_cbranch_scc1 L_h_hook_sig
L_h_hook_ret:
    v_mfma_f32_16x16x32_bf16 v[20:23], a[76:79], a[20:23], v[20:23]
    ds_read_b64_tr_b16 a[40:41], v246 offset:0
    v_mfma_f32_16x16x32_bf16 v[48:51], a[76:79], a[24:27], v[48:51]
    s_add_u32 m0, s54, 0
    ds_read_b64_tr_b16 a[42:43], v246 offset:3584
    v_mfma_f32_16x16x32_bf16 v[76:79], a[76:79], a[28:31], v[76:79]
    buffer_load_dwordx4 v4, s[20:23], s55 offen lds
    v_mfma_f32_16x16x32_bf16 v[104:107], a[76:79], a[32:35], v[104:107]
    ds_read_b128 a[0:3], v244 offset:0
    v_mfma_f32_16x16x32_bf16 v[24:27], a[80:83], a[20:23], v[24:27]
    ds_read_b128 a[4:7], v244 offset:2048
    v_mfma_f32_16x16x32_bf16 v[52:55], a[80:83], a[24:27], v[52:55]
    s_add_u32 m0, s54, 4096
    ds_read_b128 a[8:11], v244 offset:4096
    v_mfma_f32_16x16x32_bf16 v[80:83], a[80:83], a[28:31], v[80:83]
    buffer_load_dwordx4 v5, s[20:23], s55 offen lds
    v_mfma_f32_16x16x32_bf16 v[108:111], a[80:83], a[32:35], v[108:111]
    ds_read_b128 a[12:15], v244 offset:6144
    v_mfma_f32_16x16x32_bf16 v[28:31], a[84:87], a[20:23], v[28:31]
    s_add_u32 m0, s54, 28672
    ds_read_b64_tr_b16 a[44:45], v247 offset:32
    v_mfma_f32_16x16x32_bf16 v[56:59], a[84:87], a[24:27], v[56:59]
    buffer_load_dwordx4 v12, s[16:19], s56 offen lds
    v_mfma_f32_16x16x32_bf16 v[84:87], a[84:87], a[28:31], v[84:87]
    ds_read_b64_tr_b16 a[46:47], v247 offset:3616
    v_mfma_f32_16x16x32_bf16 v[112:115], a[84:87], a[32:35], v[112:115]
    ds_read_b64_tr_b16 a[48:49], v246 offset:64
    v_mfma_f32_16x16x32_bf16 v[32:35], a[88:91], a[20:23], v[32:35]
    s_add_u32 m0, s54, 8192
    ds_read_b64_tr_b16 a[50:51], v246 offset:3648
    v_mfma_f32_16x16x32_bf16 v[60:63], a[88:91], a[24:27], v[60:63]
    buffer_load_dwordx4 v6, s[20:23], s55 offen lds
    v_mfma_f32_16x16x32_bf16 v[88:91], a[88:91], a[28:31], v[88:91]
    ds_read_b64_tr_b16 a[52:53], v247 offset:96
    v_mfma_f32_16x16x32_bf16 v[116:119], a[88:91], a[32:35], v[116:119]
    s_add_u32 m0, s54, 32768
    ds_read_b64_tr_b16 a[54:55], v247 offset:3680
    v_mfma_f32_16x16x32_bf16 v[36:39], a[92:95], a[20:23], v[36:39]
    buffer_load_dwordx4 v13, s[16:19], s56 offen lds
    v_mfma_f32_16x16x32_bf16 v[64:67], a[92:95], a[24:27], v[64:67]
    ds_read_b64_tr_b16 a[56:57], v246 offset:128
    v_mfma_f32_16x16x32_bf16 v[92:95], a[92:95], a[28:31], v[92:95]
    ds_read_b64_tr_b16 a[58:59], v246 offset:3712
    v_mfma_f32_16x16x32_bf16 v[120:123], a[92:95], a[32:35], v[120:123]
    s_add_u32 m0, s54, 12288
    ds_read_b64_tr_b16 a[60:61], v247 offset:160
    v_mfma_f32_16x16x32_bf16 v[40:43], a[96:99], a[20:23], v[40:43]
    buffer_load_dwordx4 v7, s[20:23], s55 offen lds
    v_mfma_f32_16x16x32_bf16 v[68:71], a[96:99], a[24:27], v[68:71]
    ds_read_b64_tr_b16 a[62:63], v247 offset:3744
    v_mfma_f32_16x16x32_bf16 v[96:99], a[96:99], a[28:31], v[96:99]
    ds_read_b64_tr_b16 a[64:65], v246 offset:192
    v_mfma_f32_16x16x32_bf16 v[124:127], a[96:99], a[32:35], v[124:127]
    ds_read_b64_tr_b16 a[66:67], v246 offset:3776
    s_add_u32 s60, s60, 1
    s_cmp_lt_u32 s60, 10
    s_cbranch_scc1 L_h_loop
    s_waitcnt vmcnt(0)
    s_cmp_lg_u32 s50, 0
    s_cbranch_scc1 L_h_wp_iss
    v_mov_b32 v2, 96
    global_load_dword v255, v2, s[48:49] sc1
L_h_wp_iss:
    s_mov_b32 s40, s68
    s_and_b32 s41, s69, 0xffff
    s_mov_b32 s42, 2621440
    s_mov_b32 s43, 0x20000
    s_lshl_b32 s61, s51, 7
    s_lshl_b32 s62, s52, 4
    s_add_u32 s61, s61, s62
    s_lshl_b32 s62, s50, 2
    s_add_u32 s61, s61, s62
    v_lshrrev_b32 v248, 4, v1
    v_add_u32 v254, s61, v248
    v_mul_u32_u24 v248, 1280, v254
    v_and_b32 v249, 15, v1
    v_lshlrev_b32 v249, 4, v249
    v_add_u32 v248, v248, v249
    buffer_load_dwordx4 v[160:163], v248, s[40:43], 0 offen offset:0
    buffer_load_dwordx4 v[164:167], v248, s[40:43], 0 offen offset:256
    buffer_load_dwordx4 v[168:171], v248, s[40:43], 0 offen offset:512
    buffer_load_dwordx4 v[172:175], v248, s[40:43], 0 offen offset:768
    buffer_load_dwordx4 v[176:179], v248, s[40:43], 0 offen offset:1024
    v_add_u32 v249, 159744, v249
    ds_read_b128 v[180:183], v249 offset:0
    ds_read_b128 v[184:187], v249 offset:256
    ds_read_b128 v[188:191], v249 offset:512
    ds_read_b128 v[192:195], v249 offset:768
    ds_read_b128 v[196:199], v249 offset:1024
    s_lshr_b32 s61, s50, 1
    s_mul_i32 s61, s61, 224
    s_add_u32 s61, s61, 161792
    v_lshrrev_b32 v248, 4, v1
    v_lshl_add_u32 v248, v248, 3, s61
    ds_read_b64 v[200:201], v248 offset:0
    ds_read_b64 v[202:203], v248 offset:32
    ds_read_b64 v[204:205], v248 offset:64
    ds_read_b64 v[206:207], v248 offset:96
    ds_read_b64 v[208:209], v248 offset:128
    ds_read_b64 v[210:211], v248 offset:160
    ds_read_b64 v[212:213], v248 offset:192
    s_waitcnt lgkmcnt(0)
    s_add_u32 s24, s28, 9699328
    s_addc_u32 s25, s29, 0
    s_mov_b32 s26, 131072
    s_mov_b32 s27, 0x20000
    s_cmp_ge_u32 s50, 2
    s_cbranch_scc1 L_h_epi1
    v_lshlrev_b32 v128, 16, v200
    v_and_b32 v129, 0xffff0000, v200
    v_lshlrev_b32 v130, 16, v201
    v_and_b32 v131, 0xffff0000, v201
    v_lshlrev_b32 v132, 16, v202
    v_and_b32 v133, 0xffff0000, v202
    v_lshlrev_b32 v134, 16, v203
    v_and_b32 v135, 0xffff0000, v203
    v_lshlrev_b32 v136, 16, v204
    v_and_b32 v137, 0xffff0000, v204
    v_lshlrev_b32 v138, 16, v205
    v_and_b32 v139, 0xffff0000, v205
    v_lshlrev_b32 v140, 16, v206
    v_and_b32 v141, 0xffff0000, v206
    v_lshlrev_b32 v142, 16, v207
    v_and_b32 v143, 0xffff0000, v207
    v_lshlrev_b32 v144, 16, v208
    v_and_b32 v145, 0xffff0000, v208
    v_lshlrev_b32 v146, 16, v209
    v_and_b32 v147, 0xffff0000, v209
    v_lshlrev_b32 v148, 16, v210
    v_and_b32 v149, 0xffff0000, v210
    v_lshlrev_b32 v150, 16, v211
    v_and_b32 v151, 0xffff0000, v211
    v_lshlrev_b32 v152, 16, v212
    v_and_b32 v153, 0xffff0000, v212
    v_lshlrev_b32 v154, 16, v213
    v_and_b32 v155, 0xffff0000, v213
    s_lshl_b32 s61, s51, 3
    s_and_b32 s62, s50, 1
    s_lshl_b32 s62, s62, 2
    s_add_u32 s61, s61, s62
    s_mul_i32 s61, s61, 75776
    s_lshl_b32 s62, s58, 4
    s_add_u32 s61, s61, s62
    v_lshlrev_b32 v248, 4, v1
    v_add_u32 v248, s61, v248
    s_and_b32 s62, s50, 1
    s_lshl_b32 s62, s62, 11
    s_add_u32 s62, s62, 135168
    v_lshl_add_u32 v250, v1, 3, s62
    v_add_u32 v249, 4096, v248
    v_pk_add_f32 v[16:17], v[16:17], v[128:129]
    v_pk_add_f32 v[18:19], v[18:19], v[130:131]
    v_max_f32 v16, 0, v16
    v_max_f32 v17, 0, v17
    v_max_f32 v18, 0, v18
    v_max_f32 v19, 0, v19
    v_pk_mul_f32 v[16:17], v[16:17], v[16:17]
    v_pk_mul_f32 v[18:19], v[18:19], v[18:19]
    v_cvt_pk_bf16_f32 v214, v16, v17
    v_cvt_pk_bf16_f32 v215, v18, v19
    v_pk_add_f32 v[20:21], v[20:21], v[132:133]
    v_pk_add_f32 v[22:23], v[22:23], v[134:135]
    v_max_f32 v20, 0, v20
    v_max_f32 v21, 0, v21
    v_max_f32 v22, 0, v22
    v_max_f32 v23, 0, v23
    v_pk_mul_f32 v[20:21], v[20:21], v[20:21]
    v_pk_mul_f32 v[22:23], v[22:23], v[22:23]
    v_cvt_pk_bf16_f32 v216, v20, v21
    v_cvt_pk_bf16_f32 v217, v22, v23
    buffer_store_dwordx4 v[214:217], v248, s[28:31], 0 offen offset:0 sc1
    v_pk_add_f32 v[24:25], v[24:25], v[136:137]
    v_pk_add_f32 v[26:27], v[26:27], v[138:139]
    v_max_f32 v24, 0, v24
    v_max_f32 v25, 0, v25
    v_max_f32 v26, 0, v26
    v_max_f32 v27, 0, v27
    v_pk_mul_f32 v[24:25], v[24:25], v[24:25]
    v_pk_mul_f32 v[26:27], v[26:27], v[26:27]
    v_cvt_pk_bf16_f32 v218, v24, v25
    v_cvt_pk_bf16_f32 v219, v26, v27
    v_pk_add_f32 v[28:29], v[28:29], v[140:141]
    v_pk_add_f32 v[30:31], v[30:31], v[142:143]
    v_max_f32 v28, 0, v28
    v_max_f32 v29, 0, v29
    v_max_f32 v30, 0, v30
    v_max_f32 v31, 0, v31
    v_pk_mul_f32 v[28:29], v[28:29], v[28:29]
    v_pk_mul_f32 v[30:31], v[30:31], v[30:31]
    v_cvt_pk_bf16_f32 v220, v28, v29
    v_cvt_pk_bf16_f32 v221, v30, v31
    buffer_store_dwordx4 v[218:221], v248, s[28:31], 0 offen offset:1024 sc1
    v_pk_add_f32 v[32:33], v[32:33], v[144:145]
    v_pk_add_f32 v[34:35], v[34:35], v[146:147]
    v_max_f32 v32, 0, v32
    v_max_f32 v33, 0, v33
    v_max_f32 v34, 0, v34
    v_max_f32 v35, 0, v35
    v_pk_mul_f32 v[32:33], v[32:33], v[32:33]
    v_pk_mul_f32 v[34:35], v[34:35], v[34:35]
    v_cvt_pk_bf16_f32 v222, v32, v33
    v_cvt_pk_bf16_f32 v223, v34, v35
    v_pk_add_f32 v[36:37], v[36:37], v[148:149]
    v_pk_add_f32 v[38:39], v[38:39], v[150:151]
    v_max_f32 v36, 0, v36
    v_max_f32 v37, 0, v37
    v_max_f32 v38, 0, v38
    v_max_f32 v39, 0, v39
    v_pk_mul_f32 v[36:37], v[36:37], v[36:37]
    v_pk_mul_f32 v[38:39], v[38:39], v[38:39]
    v_cvt_pk_bf16_f32 v224, v36, v37
    v_cvt_pk_bf16_f32 v225, v38, v39
    buffer_store_dwordx4 v[222:225], v248, s[28:31], 0 offen offset:2048 sc1
    v_pk_add_f32 v[40:41], v[40:41], v[152:153]
    v_pk_add_f32 v[42:43], v[42:43], v[154:155]
    v_max_f32 v40, 0, v40
    v_max_f32 v41, 0, v41
    v_max_f32 v42, 0, v42
    v_max_f32 v43, 0, v43
    v_pk_mul_f32 v[40:41], v[40:41], v[40:41]
    v_pk_mul_f32 v[42:43], v[42:43], v[42:43]
    v_cvt_pk_bf16_f32 v232, v40, v41
    v_cvt_pk_bf16_f32 v233, v42, v43
    v_add_u32 v248, 75776, v248
    v_add_u32 v249, 4096, v248
    v_pk_add_f32 v[44:45], v[44:45], v[128:129]
    v_pk_add_f32 v[46:47], v[46:47], v[130:131]
    v_max_f32 v44, 0, v44
    v_max_f32 v45, 0, v45
    v_max_f32 v46, 0, v46
    v_max_f32 v47, 0, v47
    v_pk_mul_f32 v[44:45], v[44:45], v[44:45]
    v_pk_mul_f32 v[46:47], v[46:47], v[46:47]
    v_cvt_pk_bf16_f32 v226, v44, v45
    v_cvt_pk_bf16_f32 v227, v46, v47
    v_pk_add_f32 v[48:49], v[48:49], v[132:133]
    v_pk_add_f32 v[50:51], v[50:51], v[134:135]
    v_max_f32 v48, 0, v48
    v_max_f32 v49, 0, v49
    v_max_f32 v50, 0, v50
    v_max_f32 v51, 0, v51
    v_pk_mul_f32 v[48:49], v[48:49], v[48:49]
    v_pk_mul_f32 v[50:51], v[50:51], v[50:51]
    v_cvt_pk_bf16_f32 v228, v48, v49
    v_cvt_pk_bf16_f32 v229, v50, v51
    buffer_store_dwordx4 v[226:229], v248, s[28:31], 0 offen offset:0 sc1
    v_pk_add_f32 v[52:53], v[52:53], v[136:137]
    v_pk_add_f32 v[54:55], v[54:55], v[138:139]
    v_max_f32 v52, 0, v52
    v_max_f32 v53, 0, v53
    v_max_f32 v54, 0, v54
    v_max_f32 v55, 0, v55
    v_pk_mul_f32 v[52:53], v[52:53], v[52:53]
    v_pk_mul_f32 v[54:55], v[54:55], v[54:55]
    v_cvt_pk_bf16_f32 v214, v52, v53
    v_cvt_pk_bf16_f32 v215, v54, v55
    v_pk_add_f32 v[56:57], v[56:57], v[140:141]
    v_pk_add_f32 v[58:59], v[58:59], v[142:143]
    v_max_f32 v56, 0, v56
    v_max_f32 v57, 0, v57
    v_max_f32 v58, 0, v58
    v_max_f32 v59, 0, v59
    v_pk_mul_f32 v[56:57], v[56:57], v[56:57]
    v_pk_mul_f32 v[58:59], v[58:59], v[58:59]
    v_cvt_pk_bf16_f32 v216, v56, v57
    v_cvt_pk_bf16_f32 v217, v58, v59
    buffer_store_dwordx4 v[214:217], v248, s[28:31], 0 offen offset:1024 sc1
    v_pk_add_f32 v[60:61], v[60:61], v[144:145]
    v_pk_add_f32 v[62:63], v[62:63], v[146:147]
    v_max_f32 v60, 0, v60
    v_max_f32 v61, 0, v61
    v_max_f32 v62, 0, v62
    v_max_f32 v63, 0, v63
    v_pk_mul_f32 v[60:61], v[60:61], v[60:61]
    v_pk_mul_f32 v[62:63], v[62:63], v[62:63]
    v_cvt_pk_bf16_f32 v218, v60, v61
    v_cvt_pk_bf16_f32 v219, v62, v63
    v_pk_add_f32 v[64:65], v[64:65], v[148:149]
    v_pk_add_f32 v[66:67], v[66:67], v[150:151]
    v_max_f32 v64, 0, v64
    v_max_f32 v65, 0, v65
    v_max_f32 v66, 0, v66
    v_max_f32 v67, 0, v67
    v_pk_mul_f32 v[64:65], v[64:65], v[64:65]
    v_pk_mul_f32 v[66:67], v[66:67], v[66:67]
    v_cvt_pk_bf16_f32 v220, v64, v65
    v_cvt_pk_bf16_f32 v221, v66, v67
    buffer_store_dwordx4 v[218:221], v248, s[28:31], 0 offen offset:2048 sc1
    v_pk_add_f32 v[68:69], v[68:69], v[152:153]
    v_pk_add_f32 v[70:71], v[70:71], v[154:155]
    v_max_f32 v68, 0, v68
    v_max_f32 v69, 0, v69
    v_max_f32 v70, 0, v70
    v_max_f32 v71, 0, v71
    v_pk_mul_f32 v[68:69], v[68:69], v[68:69]
    v_pk_mul_f32 v[70:71], v[70:71], v[70:71]
    v_cvt_pk_bf16_f32 v234, v68, v69
    v_cvt_pk_bf16_f32 v235, v70, v71
    v_add_u32 v248, 75776, v248
    v_add_u32 v249, 4096, v248
    v_pk_add_f32 v[72:73], v[72:73], v[128:129]
    v_pk_add_f32 v[74:75], v[74:75], v[130:131]
    v_max_f32 v72, 0, v72
    v_max_f32 v73, 0, v73
    v_max_f32 v74, 0, v74
    v_max_f32 v75, 0, v75
    v_pk_mul_f32 v[72:73], v[72:73], v[72:73]
    v_pk_mul_f32 v[74:75], v[74:75], v[74:75]
    v_cvt_pk_bf16_f32 v222, v72, v73
    v_cvt_pk_bf16_f32 v223, v74, v75
    v_pk_add_f32 v[76:77], v[76:77], v[132:133]
    v_pk_add_f32 v[78:79], v[78:79], v[134:135]
    v_max_f32 v76, 0, v76
    v_max_f32 v77, 0, v77
    v_max_f32 v78, 0, v78
    v_max_f32 v79, 0, v79
    v_pk_mul_f32 v[76:77], v[76:77], v[76:77]
    v_pk_mul_f32 v[78:79], v[78:79], v[78:79]
    v_cvt_pk_bf16_f32 v224, v76, v77
    v_cvt_pk_bf16_f32 v225, v78, v79
    buffer_store_dwordx4 v[222:225], v248, s[28:31], 0 offen offset:0 sc1
    v_pk_add_f32 v[80:81], v[80:81], v[136:137]
    v_pk_add_f32 v[82:83], v[82:83], v[138:139]
    v_max_f32 v80, 0, v80
    v_max_f32 v81, 0, v81
    v_max_f32 v82, 0, v82
    v_max_f32 v83, 0, v83
    v_pk_mul_f32 v[80:81], v[80:81], v[80:81]
    v_pk_mul_f32 v[82:83], v[82:83], v[82:83]
    v_cvt_pk_bf16_f32 v226, v80, v81
    v_cvt_pk_bf16_f32 v227, v82, v83
    v_pk_add_f32 v[84:85], v[84:85], v[140:141]
    v_pk_add_f32 v[86:87], v[86:87], v[142:143]
    v_max_f32 v84, 0, v84
    v_max_f32 v85, 0, v85
    v_max_f32 v86, 0, v86
    v_max_f32 v87, 0, v87
    v_pk_mul_f32 v[84:85], v[84:85], v[84:85]
    v_pk_mul_f32 v[86:87], v[86:87], v[86:87]
    v_cvt_pk_bf16_f32 v228, v84, v85
    v_cvt_pk_bf16_f32 v229, v86, v87
    buffer_store_dwordx4 v[226:229], v248, s[28:31], 0 offen offset:1024 sc1
    v_pk_add_f32 v[88:89], v[88:89], v[144:145]
    v_pk_add_f32 v[90:91], v[90:91], v[146:147]
    v_max_f32 v88, 0, v88
    v_max_f32 v89, 0, v89
    v_max_f32 v90, 0, v90
    v_max_f32 v91, 0, v91
    v_pk_mul_f32 v[88:89], v[88:89], v[88:89]
    v_pk_mul_f32 v[90:91], v[90:91], v[90:91]
    v_cvt_pk_bf16_f32 v214, v88, v89
    v_cvt_pk_bf16_f32 v215, v90, v91
    v_pk_add_f32 v[92:93], v[92:93], v[148:149]
    v_pk_add_f32 v[94:95], v[94:95], v[150:151]
    v_max_f32 v92, 0, v92
    v_max_f32 v93, 0, v93
    v_max_f32 v94, 0, v94
    v_max_f32 v95, 0, v95
    v_pk_mul_f32 v[92:93], v[92:93], v[92:93]
    v_pk_mul_f32 v[94:95], v[94:95], v[94:95]
    v_cvt_pk_bf16_f32 v216, v92, v93
    v_cvt_pk_bf16_f32 v217, v94, v95
    buffer_store_dwordx4 v[214:217], v248, s[28:31], 0 offen offset:2048 sc1
    v_pk_add_f32 v[96:97], v[96:97], v[152:153]
    v_pk_add_f32 v[98:99], v[98:99], v[154:155]
    v_max_f32 v96, 0, v96
    v_max_f32 v97, 0, v97
    v_max_f32 v98, 0, v98
    v_max_f32 v99, 0, v99
    v_pk_mul_f32 v[96:97], v[96:97], v[96:97]
    v_pk_mul_f32 v[98:99], v[98:99], v[98:99]
    v_cvt_pk_bf16_f32 v236, v96, v97
    v_cvt_pk_bf16_f32 v237, v98, v99
    v_add_u32 v248, 75776, v248
    v_add_u32 v249, 4096, v248
    v_pk_add_f32 v[100:101], v[100:101], v[128:129]
    v_pk_add_f32 v[102:103], v[102:103], v[130:131]
    v_max_f32 v100, 0, v100
    v_max_f32 v101, 0, v101
    v_max_f32 v102, 0, v102
    v_max_f32 v103, 0, v103
    v_pk_mul_f32 v[100:101], v[100:101], v[100:101]
    v_pk_mul_f32 v[102:103], v[102:103], v[102:103]
    v_cvt_pk_bf16_f32 v218, v100, v101
    v_cvt_pk_bf16_f32 v219, v102, v103
    v_pk_add_f32 v[104:105], v[104:105], v[132:133]
    v_pk_add_f32 v[106:107], v[106:107], v[134:135]
    v_max_f32 v104, 0, v104
    v_max_f32 v105, 0, v105
    v_max_f32 v106, 0, v106
    v_max_f32 v107, 0, v107
    v_pk_mul_f32 v[104:105], v[104:105], v[104:105]
    v_pk_mul_f32 v[106:107], v[106:107], v[106:107]
    v_cvt_pk_bf16_f32 v220, v104, v105
    v_cvt_pk_bf16_f32 v221, v106, v107
    buffer_store_dwordx4 v[218:221], v248, s[28:31], 0 offen offset:0 sc1
    v_pk_add_f32 v[108:109], v[108:109], v[136:137]
    v_pk_add_f32 v[110:111], v[110:111], v[138:139]
    v_max_f32 v108, 0, v108
    v_max_f32 v109, 0, v109
    v_max_f32 v110, 0, v110
    v_max_f32 v111, 0, v111
    v_pk_mul_f32 v[108:109], v[108:109], v[108:109]
    v_pk_mul_f32 v[110:111], v[110:111], v[110:111]
    v_cvt_pk_bf16_f32 v222, v108, v109
    v_cvt_pk_bf16_f32 v223, v110, v111
    v_pk_add_f32 v[112:113], v[112:113], v[140:141]
    v_pk_add_f32 v[114:115], v[114:115], v[142:143]
    v_max_f32 v112, 0, v112
    v_max_f32 v113, 0, v113
    v_max_f32 v114, 0, v114
    v_max_f32 v115, 0, v115
    v_pk_mul_f32 v[112:113], v[112:113], v[112:113]
    v_pk_mul_f32 v[114:115], v[114:115], v[114:115]
    v_cvt_pk_bf16_f32 v224, v112, v113
    v_cvt_pk_bf16_f32 v225, v114, v115
    buffer_store_dwordx4 v[222:225], v248, s[28:31], 0 offen offset:1024 sc1
    v_pk_add_f32 v[116:117], v[116:117], v[144:145]
    v_pk_add_f32 v[118:119], v[118:119], v[146:147]
    v_max_f32 v116, 0, v116
    v_max_f32 v117, 0, v117
    v_max_f32 v118, 0, v118
    v_max_f32 v119, 0, v119
    v_pk_mul_f32 v[116:117], v[116:117], v[116:117]
    v_pk_mul_f32 v[118:119], v[118:119], v[118:119]
    v_cvt_pk_bf16_f32 v226, v116, v117
    v_cvt_pk_bf16_f32 v227, v118, v119
    v_pk_add_f32 v[120:121], v[120:121], v[148:149]
    v_pk_add_f32 v[122:123], v[122:123], v[150:151]
    v_max_f32 v120, 0, v120
    v_max_f32 v121, 0, v121
    v_max_f32 v122, 0, v122
    v_max_f32 v123, 0, v123
    v_pk_mul_f32 v[120:121], v[120:121], v[120:121]
    v_pk_mul_f32 v[122:123], v[122:123], v[122:123]
    v_cvt_pk_bf16_f32 v228, v120, v121
    v_cvt_pk_bf16_f32 v229, v122, v123
    buffer_store_dwordx4 v[226:229], v248, s[28:31], 0 offen offset:2048 sc1
    v_pk_add_f32 v[124:125], v[124:125], v[152:153]
    v_pk_add_f32 v[126:127], v[126:127], v[154:155]
    v_max_f32 v124, 0, v124
    v_max_f32 v125, 0, v125
    v_max_f32 v126, 0, v126
    v_max_f32 v127, 0, v127
    v_pk_mul_f32 v[124:125], v[124:125], v[124:125]
    v_pk_mul_f32 v[126:127], v[126:127], v[126:127]
    v_cvt_pk_bf16_f32 v238, v124, v125
    v_cvt_pk_bf16_f32 v239, v126, v127
    s_cmp_lg_u32 s50, 0
    s_cbranch_scc1 L_wp_pollh_skip
    s_waitcnt vmcnt(17)
    v_readfirstlane_b32 s61, v255
    s_nop 3
    s_cmp_ge_u32 s61, 128
    s_cbranch_scc1 L_wp_pollh_skip
    v_mov_b32 v2, 96
    s_mov_b32 s15, 400000
L_wp_pollh:
    global_load_dword v3, v2, s[48:49] sc1
    s_sub_u32 s15, s15, 1
    s_cbranch_scc1 L_wp_pollh_out
    s_waitcnt vmcnt(0)
    v_readfirstlane_b32 s61, v3
    s_nop 3
    s_cmp_ge_u32 s61, 128
    s_cbranch_scc1 L_wp_pollh_out
    s_sleep 1
    s_branch L_wp_pollh
L_wp_pollh_out:
L_wp_pollh_skip:
    s_waitcnt lgkmcnt(0)
    s_barrier
    v_subrev_u32 v248, 227328, v248
    v_mov_b64 v[214:215], v[232:233]
    ds_read_b64 v[216:217], v250 offset:0
    v_mov_b64 v[218:219], v[234:235]
    ds_read_b64 v[220:221], v250 offset:512
    v_mov_b64 v[222:223], v[236:237]
    ds_read_b64 v[224:225], v250 offset:1024
    v_mov_b64 v[226:227], v[238:239]
    ds_read_b64 v[228:229], v250 offset:1536
    s_waitcnt lgkmcnt(3)
    buffer_store_dwordx4 v[214:217], v248, s[28:31], 0 offen offset:3072 sc1
    v_add_u32 v248, 75776, v248
    s_waitcnt lgkmcnt(2)
    buffer_store_dwordx4 v[218:221], v248, s[28:31], 0 offen offset:3072 sc1
    v_add_u32 v248, 75776, v248
    s_waitcnt lgkmcnt(1)
    buffer_store_dwordx4 v[222:225], v248, s[28:31], 0 offen offset:3072 sc1
    v_add_u32 v248, 75776, v248
    s_waitcnt lgkmcnt(0)
    buffer_store_dwordx4 v[226:229], v248, s[28:31], 0 offen offset:3072 sc1
    s_branch L_h_done
L_h_epi1:
    v_lshlrev_b32 v128, 16, v200
    v_and_b32 v129, 0xffff0000, v200
    v_lshlrev_b32 v130, 16, v201
    v_and_b32 v131, 0xffff0000, v201
    v_lshlrev_b32 v132, 16, v202
    v_and_b32 v133, 0xffff0000, v202
    v_lshlrev_b32 v134, 16, v203
    v_and_b32 v135, 0xffff0000, v203
    v_lshlrev_b32 v136, 16, v204
    v_and_b32 v137, 0xffff0000, v204
    v_lshlrev_b32 v138, 16, v205
    v_and_b32 v139, 0xffff0000, v205
    v_lshlrev_b32 v140, 16, v206
    v_and_b32 v141, 0xffff0000, v206
    v_lshlrev_b32 v142, 16, v207
    v_and_b32 v143, 0xffff0000, v207
    v_lshlrev_b32 v144, 16, v208
    v_and_b32 v145, 0xffff0000, v208
    v_lshlrev_b32 v146, 16, v209
    v_and_b32 v147, 0xffff0000, v209
    v_lshlrev_b32 v148, 16, v210
    v_and_b32 v149, 0xffff0000, v210
    v_lshlrev_b32 v150, 16, v211
    v_and_b32 v151, 0xffff0000, v211
    v_lshlrev_b32 v152, 16, v212
    v_and_b32 v153, 0xffff0000, v212
    v_lshlrev_b32 v154, 16, v213
    v_and_b32 v155, 0xffff0000, v213
    s_lshl_b32 s61, s51, 3
    s_and_b32 s62, s50, 1
    s_lshl_b32 s62, s62, 2
    s_add_u32 s61, s61, s62
    s_mul_i32 s61, s61, 75776
    s_lshl_b32 s62, s58, 4
    s_add_u32 s61, s61, s62
    v_lshlrev_b32 v248, 4, v1
    v_add_u32 v248, s61, v248
    s_and_b32 s62, s50, 1
    s_lshl_b32 s62, s62, 11
    s_add_u32 s62, s62, 135168
    v_lshl_add_u32 v250, v1, 3, s62
    v_add_u32 v249, 4096, v248
    v_pk_add_f32 v[16:17], v[16:17], v[128:129]
    v_pk_add_f32 v[18:19], v[18:19], v[130:131]
    v_max_f32 v16, 0, v16
    v_max_f32 v17, 0, v17
    v_max_f32 v18, 0, v18
    v_max_f32 v19, 0, v19
    v_pk_mul_f32 v[16:17], v[16:17], v[16:17]
    v_pk_mul_f32 v[18:19], v[18:19], v[18:19]
    v_cvt_pk_bf16_f32 v216, v16, v17
    v_cvt_pk_bf16_f32 v217, v18, v19
    ds_write_b64 v250, v[216:217] offset:0
    v_pk_add_f32 v[20:21], v[20:21], v[132:133]
    v_pk_add_f32 v[22:23], v[22:23], v[134:135]
    v_max_f32 v20, 0, v20
    v_max_f32 v21, 0, v21
    v_max_f32 v22, 0, v22
    v_max_f32 v23, 0, v23
    v_pk_mul_f32 v[20:21], v[20:21], v[20:21]
    v_pk_mul_f32 v[22:23], v[22:23], v[22:23]
    v_cvt_pk_bf16_f32 v218, v20, v21
    v_cvt_pk_bf16_f32 v219, v22, v23
    v_pk_add_f32 v[24:25], v[24:25], v[136:137]
    v_pk_add_f32 v[26:27], v[26:27], v[138:139]
    v_max_f32 v24, 0, v24
    v_max_f32 v25, 0, v25
    v_max_f32 v26, 0, v26
    v_max_f32 v27, 0, v27
    v_pk_mul_f32 v[24:25], v[24:25], v[24:25]
    v_pk_mul_f32 v[26:27], v[26:27], v[26:27]
    v_cvt_pk_bf16_f32 v220, v24, v25
    v_cvt_pk_bf16_f32 v221, v26, v27
    buffer_store_dwordx4 v[218:221], v249, s[28:31], 0 offen offset:0 sc1
    v_pk_add_f32 v[28:29], v[28:29], v[140:141]
    v_pk_add_f32 v[30:31], v[30:31], v[142:143]
    v_max_f32 v28, 0, v28
    v_max_f32 v29, 0, v29
    v_max_f32 v30, 0, v30
    v_max_f32 v31, 0, v31
    v_pk_mul_f32 v[28:29], v[28:29], v[28:29]
    v_pk_mul_f32 v[30:31], v[30:31], v[30:31]
    v_cvt_pk_bf16_f32 v222, v28, v29
    v_cvt_pk_bf16_f32 v223, v30, v31
    v_pk_add_f32 v[32:33], v[32:33], v[144:145]
    v_pk_add_f32 v[34:35], v[34:35], v[146:147]
    v_max_f32 v32, 0, v32
    v_max_f32 v33, 0, v33
    v_max_f32 v34, 0, v34
    v_max_f32 v35, 0, v35
    v_pk_mul_f32 v[32:33], v[32:33], v[32:33]
    v_pk_mul_f32 v[34:35], v[34:35], v[34:35]
    v_cvt_pk_bf16_f32 v224, v32, v33
    v_cvt_pk_bf16_f32 v225, v34, v35
    buffer_store_dwordx4 v[222:225], v249, s[28:31], 0 offen offset:1024 sc1
    v_pk_add_f32 v[36:37], v[36:37], v[148:149]
    v_pk_add_f32 v[38:39], v[38:39], v[150:151]
    v_max_f32 v36, 0, v36
    v_max_f32 v37, 0, v37
    v_max_f32 v38, 0, v38
    v_max_f32 v39, 0, v39
    v_pk_mul_f32 v[36:37], v[36:37], v[36:37]
    v_pk_mul_f32 v[38:39], v[38:39], v[38:39]
    v_cvt_pk_bf16_f32 v226, v36, v37
    v_cvt_pk_bf16_f32 v227, v38, v39
    v_pk_add_f32 v[40:41], v[40:41], v[152:153]
    v_pk_add_f32 v[42:43], v[42:43], v[154:155]
    v_max_f32 v40, 0, v40
    v_max_f32 v41, 0, v41
    v_max_f32 v42, 0, v42
    v_max_f32 v43, 0, v43
    v_pk_mul_f32 v[40:41], v[40:41], v[40:41]
    v_pk_mul_f32 v[42:43], v[42:43], v[42:43]
    v_cvt_pk_bf16_f32 v228, v40, v41
    v_cvt_pk_bf16_f32 v229, v42, v43
    buffer_store_dwordx4 v[226:229], v249, s[28:31], 0 offen offset:2048 sc1
    v_add_u32 v248, 75776, v248
    v_add_u32 v249, 4096, v248
    v_pk_add_f32 v[44:45], v[44:45], v[128:129]
    v_pk_add_f32 v[46:47], v[46:47], v[130:131]
    v_max_f32 v44, 0, v44
    v_max_f32 v45, 0, v45
    v_max_f32 v46, 0, v46
    v_max_f32 v47, 0, v47
    v_pk_mul_f32 v[44:45], v[44:45], v[44:45]
    v_pk_mul_f32 v[46:47], v[46:47], v[46:47]
    v_cvt_pk_bf16_f32 v216, v44, v45
    v_cvt_pk_bf16_f32 v217, v46, v47
    ds_write_b64 v250, v[216:217] offset:512
    v_pk_add_f32 v[48:49], v[48:49], v[132:133]
    v_pk_add_f32 v[50:51], v[50:51], v[134:135]
    v_max_f32 v48, 0, v48
    v_max_f32 v49, 0, v49
    v_max_f32 v50, 0, v50
    v_max_f32 v51, 0, v51
    v_pk_mul_f32 v[48:49], v[48:49], v[48:49]
    v_pk_mul_f32 v[50:51], v[50:51], v[50:51]
    v_cvt_pk_bf16_f32 v218, v48, v49
    v_cvt_pk_bf16_f32 v219, v50, v51
    v_pk_add_f32 v[52:53], v[52:53], v[136:137]
    v_pk_add_f32 v[54:55], v[54:55], v[138:139]
    v_max_f32 v52, 0, v52
    v_max_f32 v53, 0, v53
    v_max_f32 v54, 0, v54
    v_max_f32 v55, 0, v55
    v_pk_mul_f32 v[52:53], v[52:53], v[52:53]
    v_pk_mul_f32 v[54:55], v[54:55], v[54:55]
    v_cvt_pk_bf16_f32 v220, v52, v53
    v_cvt_pk_bf16_f32 v221, v54, v55
    buffer_store_dwordx4 v[218:221], v249, s[28:31], 0 offen offset:0 sc1
    v_pk_add_f32 v[56:57], v[56:57], v[140:141]
    v_pk_add_f32 v[58:59], v[58:59], v[142:143]
    v_max_f32 v56, 0, v56
    v_max_f32 v57, 0, v57
    v_max_f32 v58, 0, v58
    v_max_f32 v59, 0, v59
    v_pk_mul_f32 v[56:57], v[56:57], v[56:57]
    v_pk_mul_f32 v[58:59], v[58:59], v[58:59]
    v_cvt_pk_bf16_f32 v222, v56, v57
    v_cvt_pk_bf16_f32 v223, v58, v59
    v_pk_add_f32 v[60:61], v[60:61], v[144:145]
    v_pk_add_f32 v[62:63], v[62:63], v[146:147]
    v_max_f32 v60, 0, v60
    v_max_f32 v61, 0, v61
    v_max_f32 v62, 0, v62
    v_max_f32 v63, 0, v63
    v_pk_mul_f32 v[60:61], v[60:61], v[60:61]
    v_pk_mul_f32 v[62:63], v[62:63], v[62:63]
    v_cvt_pk_bf16_f32 v224, v60, v61
    v_cvt_pk_bf16_f32 v225, v62, v63
    buffer_store_dwordx4 v[222:225], v249, s[28:31], 0 offen offset:1024 sc1
    v_pk_add_f32 v[64:65], v[64:65], v[148:149]
    v_pk_add_f32 v[66:67], v[66:67], v[150:151]
    v_max_f32 v64, 0, v64
    v_max_f32 v65, 0, v65
    v_max_f32 v66, 0, v66
    v_max_f32 v67, 0, v67
    v_pk_mul_f32 v[64:65], v[64:65], v[64:65]
    v_pk_mul_f32 v[66:67], v[66:67], v[66:67]
    v_cvt_pk_bf16_f32 v226, v64, v65
    v_cvt_pk_bf16_f32 v227, v66, v67
    v_pk_add_f32 v[68:69], v[68:69], v[152:153]
    v_pk_add_f32 v[70:71], v[70:71], v[154:155]
    v_max_f32 v68, 0, v68
    v_max_f32 v69, 0, v69
    v_max_f32 v70, 0, v70
    v_max_f32 v71, 0, v71
    v_pk_mul_f32 v[68:69], v[68:69], v[68:69]
    v_pk_mul_f32 v[70:71], v[70:71], v[70:71]
    v_cvt_pk_bf16_f32 v228, v68, v69
    v_cvt_pk_bf16_f32 v229, v70, v71
    buffer_store_dwordx4 v[226:229], v249, s[28:31], 0 offen offset:2048 sc1
    v_add_u32 v248, 75776, v248
    v_add_u32 v249, 4096, v248
    v_pk_add_f32 v[72:73], v[72:73], v[128:129]
    v_pk_add_f32 v[74:75], v[74:75], v[130:131]
    v_max_f32 v72, 0, v72
    v_max_f32 v73, 0, v73
    v_max_f32 v74, 0, v74
    v_max_f32 v75, 0, v75
    v_pk_mul_f32 v[72:73], v[72:73], v[72:73]
    v_pk_mul_f32 v[74:75], v[74:75], v[74:75]
    v_cvt_pk_bf16_f32 v216, v72, v73
    v_cvt_pk_bf16_f32 v217, v74, v75
    ds_write_b64 v250, v[216:217] offset:1024
    v_pk_add_f32 v[76:77], v[76:77], v[132:133]
    v_pk_add_f32 v[78:79], v[78:79], v[134:135]
    v_max_f32 v76, 0, v76
    v_max_f32 v77, 0, v77
    v_max_f32 v78, 0, v78
    v_max_f32 v79, 0, v79
    v_pk_mul_f32 v[76:77], v[76:77], v[76:77]
    v_pk_mul_f32 v[78:79], v[78:79], v[78:79]
    v_cvt_pk_bf16_f32 v218, v76, v77
    v_cvt_pk_bf16_f32 v219, v78, v79
    v_pk_add_f32 v[80:81], v[80:81], v[136:137]
    v_pk_add_f32 v[82:83], v[82:83], v[138:139]
    v_max_f32 v80, 0, v80
    v_max_f32 v81, 0, v81
    v_max_f32 v82, 0, v82
    v_max_f32 v83, 0, v83
    v_pk_mul_f32 v[80:81], v[80:81], v[80:81]
    v_pk_mul_f32 v[82:83], v[82:83], v[82:83]
    v_cvt_pk_bf16_f32 v220, v80, v81
    v_cvt_pk_bf16_f32 v221, v82, v83
    buffer_store_dwordx4 v[218:221], v249, s[28:31], 0 offen offset:0 sc1
    v_pk_add_f32 v[84:85], v[84:85], v[140:141]
    v_pk_add_f32 v[86:87], v[86:87], v[142:143]
    v_max_f32 v84, 0, v84
    v_max_f32 v85, 0, v85
    v_max_f32 v86, 0, v86
    v_max_f32 v87, 0, v87
    v_pk_mul_f32 v[84:85], v[84:85], v[84:85]
    v_pk_mul_f32 v[86:87], v[86:87], v[86:87]
    v_cvt_pk_bf16_f32 v222, v84, v85
    v_cvt_pk_bf16_f32 v223, v86, v87
    v_pk_add_f32 v[88:89], v[88:89], v[144:145]
    v_pk_add_f32 v[90:91], v[90:91], v[146:147]
    v_max_f32 v88, 0, v88
    v_max_f32 v89, 0, v89
    v_max_f32 v90, 0, v90
    v_max_f32 v91, 0, v91
    v_pk_mul_f32 v[88:89], v[88:89], v[88:89]
    v_pk_mul_f32 v[90:91], v[90:91], v[90:91]
    v_cvt_pk_bf16_f32 v224, v88, v89
    v_cvt_pk_bf16_f32 v225, v90, v91
    buffer_store_dwordx4 v[222:225], v249, s[28:31], 0 offen offset:1024 sc1
    v_pk_add_f32 v[92:93], v[92:93], v[148:149]
    v_pk_add_f32 v[94:95], v[94:95], v[150:151]
    v_max_f32 v92, 0, v92
    v_max_f32 v93, 0, v93
    v_max_f32 v94, 0, v94
    v_max_f32 v95, 0, v95
    v_pk_mul_f32 v[92:93], v[92:93], v[92:93]
    v_pk_mul_f32 v[94:95], v[94:95], v[94:95]
    v_cvt_pk_bf16_f32 v226, v92, v93
    v_cvt_pk_bf16_f32 v227, v94, v95
    v_pk_add_f32 v[96:97], v[96:97], v[152:153]
    v_pk_add_f32 v[98:99], v[98:99], v[154:155]
    v_max_f32 v96, 0, v96
    v_max_f32 v97, 0, v97
    v_max_f32 v98, 0, v98
    v_max_f32 v99, 0, v99
    v_pk_mul_f32 v[96:97], v[96:97], v[96:97]
    v_pk_mul_f32 v[98:99], v[98:99], v[98:99]
    v_cvt_pk_bf16_f32 v228, v96, v97
    v_cvt_pk_bf16_f32 v229, v98, v99
    buffer_store_dwordx4 v[226:229], v249, s[28:31], 0 offen offset:2048 sc1
    v_add_u32 v248, 75776, v248
    v_add_u32 v249, 4096, v248
    v_pk_add_f32 v[100:101], v[100:101], v[128:129]
    v_pk_add_f32 v[102:103], v[102:103], v[130:131]
    v_max_f32 v100, 0, v100
    v_max_f32 v101, 0, v101
    v_max_f32 v102, 0, v102
    v_max_f32 v103, 0, v103
    v_pk_mul_f32 v[100:101], v[100:101], v[100:101]
    v_pk_mul_f32 v[102:103], v[102:103], v[102:103]
    v_cvt_pk_bf16_f32 v216, v100, v101
    v_cvt_pk_bf16_f32 v217, v102, v103
    ds_write_b64 v250, v[216:217] offset:1536
    v_pk_add_f32 v[104:105], v[104:105], v[132:133]
    v_pk_add_f32 v[106:107], v[106:107], v[134:135]
    v_max_f32 v104, 0, v104
    v_max_f32 v105, 0, v105
    v_max_f32 v106, 0, v106
    v_max_f32 v107, 0, v107
    v_pk_mul_f32 v[104:105], v[104:105], v[104:105]
    v_pk_mul_f32 v[106:107], v[106:107], v[106:107]
    v_cvt_pk_bf16_f32 v218, v104, v105
    v_cvt_pk_bf16_f32 v219, v106, v107
    v_pk_add_f32 v[108:109], v[108:109], v[136:137]
    v_pk_add_f32 v[110:111], v[110:111], v[138:139]
    v_max_f32 v108, 0, v108
    v_max_f32 v109, 0, v109
    v_max_f32 v110, 0, v110
    v_max_f32 v111, 0, v111
    v_pk_mul_f32 v[108:109], v[108:109], v[108:109]
    v_pk_mul_f32 v[110:111], v[110:111], v[110:111]
    v_cvt_pk_bf16_f32 v220, v108, v109
    v_cvt_pk_bf16_f32 v221, v110, v111
    buffer_store_dwordx4 v[218:221], v249, s[28:31], 0 offen offset:0 sc1
    v_pk_add_f32 v[112:113], v[112:113], v[140:141]
    v_pk_add_f32 v[114:115], v[114:115], v[142:143]
    v_max_f32 v112, 0, v112
    v_max_f32 v113, 0, v113
    v_max_f32 v114, 0, v114
    v_max_f32 v115, 0, v115
    v_pk_mul_f32 v[112:113], v[112:113], v[112:113]
    v_pk_mul_f32 v[114:115], v[114:115], v[114:115]
    v_cvt_pk_bf16_f32 v222, v112, v113
    v_cvt_pk_bf16_f32 v223, v114, v115
    v_pk_add_f32 v[116:117], v[116:117], v[144:145]
    v_pk_add_f32 v[118:119], v[118:119], v[146:147]
    v_max_f32 v116, 0, v116
    v_max_f32 v117, 0, v117
    v_max_f32 v118, 0, v118
    v_max_f32 v119, 0, v119
    v_pk_mul_f32 v[116:117], v[116:117], v[116:117]
    v_pk_mul_f32 v[118:119], v[118:119], v[118:119]
    v_cvt_pk_bf16_f32 v224, v116, v117
    v_cvt_pk_bf16_f32 v225, v118, v119
    buffer_store_dwordx4 v[222:225], v249, s[28:31], 0 offen offset:1024 sc1
    v_pk_add_f32 v[120:121], v[120:121], v[148:149]
    v_pk_add_f32 v[122:123], v[122:123], v[150:151]
    v_max_f32 v120, 0, v120
    v_max_f32 v121, 0, v121
    v_max_f32 v122, 0, v122
    v_max_f32 v123, 0, v123
    v_pk_mul_f32 v[120:121], v[120:121], v[120:121]
    v_pk_mul_f32 v[122:123], v[122:123], v[122:123]
    v_cvt_pk_bf16_f32 v226, v120, v121
    v_cvt_pk_bf16_f32 v227, v122, v123
    v_pk_add_f32 v[124:125], v[124:125], v[152:153]
    v_pk_add_f32 v[126:127], v[126:127], v[154:155]
    v_max_f32 v124, 0, v124
    v_max_f32 v125, 0, v125
    v_max_f32 v126, 0, v126
    v_max_f32 v127, 0, v127
    v_pk_mul_f32 v[124:125], v[124:125], v[124:125]
    v_pk_mul_f32 v[126:127], v[126:127], v[126:127]
    v_cvt_pk_bf16_f32 v228, v124, v125
    v_cvt_pk_bf16_f32 v229, v126, v127
    buffer_store_dwordx4 v[226:229], v249, s[28:31], 0 offen offset:2048 sc1
    s_waitcnt lgkmcnt(0)
    s_barrier
    s_branch L_h_done
L_h_alt0:
    s_waitcnt vmcnt(20) lgkmcnt(0)
    s_branch L_h_alt0_ret
L_h_hook_sig:
    s_cmp_lg_u32 s50, 0
    s_cbranch_scc1 L_h_wp_sig
    v_mov_b32 v2, 96
    v_mov_b32 v3, 1
    s_mov_b64 exec, 1
    global_atomic_add v2, v3, s[48:49] sc1
    s_mov_b64 exec, -1
L_h_wp_sig:
    s_branch L_h_hook_ret
L_h_done:
    s_waitcnt vmcnt(12)
    v_mov_b32 v250, 0
    v_mov_b32 v251, 0
    v_dot2_f32_bf16 v250, v160, v180, v250
    v_dot2_f32_bf16 v251, v170, v190, v251
    v_dot2_f32_bf16 v250, v161, v181, v250
    v_dot2_f32_bf16 v251, v171, v191, v251
    v_dot2_f32_bf16 v250, v162, v182, v250
    v_dot2_f32_bf16 v251, v172, v192, v251
    v_dot2_f32_bf16 v250, v163, v183, v250
    v_dot2_f32_bf16 v251, v173, v193, v251
    v_dot2_f32_bf16 v250, v164, v184, v250
    v_dot2_f32_bf16 v251, v174, v194, v251
    v_dot2_f32_bf16 v250, v165, v185, v250
    v_dot2_f32_bf16 v251, v175, v195, v251
    v_dot2_f32_bf16 v250, v166, v186, v250
    v_dot2_f32_bf16 v251, v176, v196, v251
    v_dot2_f32_bf16 v250, v167, v187, v250
    v_dot2_f32_bf16 v251, v177, v197, v251
    v_dot2_f32_bf16 v250, v168, v188, v250
    v_dot2_f32_bf16 v251, v178, v198, v251
    v_dot2_f32_bf16 v250, v169, v189, v250
    v_dot2_f32_bf16 v251, v179, v199, v251
    s_nop 2
    v_add_f32 v250, v250, v251
    s_nop 1
    v_add_f32_dpp v250, v250, v250 row_ror:8 row_mask:0xf bank_mask:0xf
    s_nop 1
    v_add_f32_dpp v250, v250, v250 row_ror:4 row_mask:0xf bank_mask:0xf
    s_nop 1
    v_add_f32_dpp v250, v250, v250 row_ror:2 row_mask:0xf bank_mask:0xf
    s_nop 1
    v_add_f32_dpp v250, v250, v250 row_ror:1 row_mask:0xf bank_mask:0xf
    v_mul_f32 v250, 0xbfb8aa3b, v250
    v_exp_f32 v250, v250
    s_nop 0
    v_add_f32 v250, 1.0, v250
    v_rcp_f32 v250, v250
    s_lshl_b32 s61, s51, 3
    s_add_u32 s61, s61, s52
    s_lshl_b32 s61, s61, 2
    s_add_u32 s61, s61, s50
    s_lshl_b32 s61, s61, 8
    v_lshl_add_u32 v251, v1, 2, s61
    buffer_store_dword v250, v251, s[24:27], 0 offen sc1
    s_mov_b32 s60, 1
    s_mul_i32 s61, s96, 5120
    s_mul_i32 s62, s50, 40960
    s_add_u32 s61, s61, s62
    v_lshlrev_b32 v240, 4, v1
    v_add_u32 v244, 0, v240
    v_add_u32 v240, s61, v240
    v_add_u32 v241, 4096, v240
    s_mul_i32 s61, s95, 303104
    s_lshl_b32 s62, s50, 10
    s_add_u32 s61, s61, s62
    v_add_u32 v244, s61, v244
    v_add_u32 v245, 75776, v244
    v_add_u32 v246, 151552, v244
    v_add_u32 v247, 227328, v244
    s_mov_b32 s3, 0
    buffer_load_dwordx4 a[0:3], v240, s[32:35], s3 offen sc1
    buffer_load_dwordx4 a[4:7], v240, s[32:35], s3 offen offset:1024 sc1
    buffer_load_dwordx4 a[8:11], v240, s[32:35], s3 offen offset:2048 sc1
    buffer_load_dwordx4 a[12:15], v240, s[32:35], s3 offen offset:3072 sc1
    buffer_load_dwordx4 a[16:19], v241, s[32:35], s3 offen sc1
    s_mov_b32 s3, 163840
    buffer_load_dwordx4 a[20:23], v240, s[32:35], s3 offen sc1
    buffer_load_dwordx4 a[24:27], v240, s[32:35], s3 offen offset:1024 sc1
    buffer_load_dwordx4 a[28:31], v240, s[32:35], s3 offen offset:2048 sc1
    buffer_load_dwordx4 a[32:35], v240, s[32:35], s3 offen offset:3072 sc1
    buffer_load_dwordx4 a[36:39], v241, s[32:35], s3 offen sc1
    s_mov_b32 s3, 327680
    buffer_load_dwordx4 a[40:43], v240, s[32:35], s3 offen sc1
    buffer_load_dwordx4 a[44:47], v240, s[32:35], s3 offen offset:1024 sc1
    buffer_load_dwordx4 a[48:51], v240, s[32:35], s3 offen offset:2048 sc1
    buffer_load_dwordx4 a[52:55], v240, s[32:35], s3 offen offset:3072 sc1
    buffer_load_dwordx4 a[56:59], v241, s[32:35], s3 offen sc1
    s_mov_b32 s3, 491520
    buffer_load_dwordx4 a[60:63], v240, s[32:35], s3 offen sc1
    s_waitcnt vmcnt(16)
    s_barrier
    s_lshr_b32 s61, s51, 1
    s_lshl_b32 s61, s61, 2
    s_bitcmp1_b32 s51, 0
    s_cselect_b32 s15, 128, 0
    s_add_u32 s61, s61, s15
    s_add_u32 s61, s61, 32
    s_cmp_lg_u32 s50, 0
    s_cbranch_scc1 L_h_sig
    v_mov_b32 v2, s61
    v_mov_b32 v3, 1
    s_mov_b64 exec, 1
    global_atomic_add v2, v3, s[48:49] sc1
    s_mov_b64 exec, -1
L_h_sig:
    s_load_dwordx2 s[36:37], s[0:1], 56
    s_mov_b32 s16, s28
    s_mov_b32 s17, s29
    s_cmp_lt_u32 s50, 2
    s_cselect_b32 s18, 9699328, 0
    s_mov_b32 s19, 0x20000
    s_mov_b32 s20, s32
    s_mov_b32 s21, s33
    s_cmp_lt_u32 s50, 2
    s_cselect_b32 s22, 3031040, 0
    s_mov_b32 s23, 0x20000
    s_add_u32 s24, s28, 9699328
    s_addc_u32 s25, s29, 0
    s_mov_b32 s26, 131072
    s_mov_b32 s27, 0x20000
    s_waitcnt lgkmcnt(0)
    s_and_b32 s37, s37, 0xffff
    s_mov_b32 s38, 1280
    s_mov_b32 s39, 0x20000
    s_mul_i32 s58, s50, 40960
    v_lshlrev_b32 v242, 4, v1
    v_add_u32 v242, s58, v242
    buffer_load_dwordx4 a[64:67], v240, s[32:35], s3 offen offset:1024 sc1
    buffer_load_dwordx4 a[68:71], v240, s[32:35], s3 offen offset:2048 sc1
    buffer_load_dwordx4 a[72:75], v240, s[32:35], s3 offen offset:3072 sc1
    buffer_load_dwordx4 a[76:79], v241, s[32:35], s3 offen sc1
    s_waitcnt vmcnt(36)
    s_mov_b32 s3, 655360
    buffer_load_dwordx4 a[80:83], v240, s[32:35], s3 offen sc1
    buffer_load_dwordx4 a[84:87], v240, s[32:35], s3 offen offset:1024 sc1
    buffer_load_dwordx4 a[88:91], v240, s[32:35], s3 offen offset:2048 sc1
    buffer_load_dwordx4 a[92:95], v240, s[32:35], s3 offen offset:3072 sc1
    buffer_load_dwordx4 a[96:99], v241, s[32:35], s3 offen sc1
    s_mov_b32 s3, 819200
    buffer_load_dwordx4 a[100:103], v240, s[32:35], s3 offen sc1
    buffer_load_dwordx4 a[104:107], v240, s[32:35], s3 offen offset:1024 sc1
    buffer_load_dwordx4 a[108:111], v240, s[32:35], s3 offen offset:2048 sc1
    buffer_load_dwordx4 a[112:115], v240, s[32:35], s3 offen offset:3072 sc1
    buffer_load_dwordx4 a[116:119], v241, s[32:35], s3 offen sc1
    s_mov_b32 s3, 983040
    buffer_load_dwordx4 a[120:123], v240, s[32:35], s3 offen sc1
    buffer_load_dwordx4 a[124:127], v240, s[32:35], s3 offen offset:1024 sc1
    buffer_load_dwordx4 a[128:131], v240, s[32:35], s3 offen offset:2048 sc1
    buffer_load_dwordx4 a[132:135], v240, s[32:35], s3 offen offset:3072 sc1
    buffer_load_dwordx4 a[136:139], v241, s[32:35], s3 offen sc1
    s_mov_b32 s3, 1146880
    s_add_u32 m0, s58, 0
    s_nop 0
    buffer_load_dwordx4 v240, s[32:35], s3 offen sc1 lds
    buffer_load_dwordx4 v240, s[32:35], s3 offen offset:1024 sc1 lds
    buffer_load_dwordx4 v240, s[32:35], s3 offen offset:2048 sc1 lds
    buffer_load_dwordx4 v240, s[32:35], s3 offen offset:3072 sc1 lds
    s_add_u32 m0, s58, 4096
    s_nop 0
    buffer_load_dwordx4 v241, s[32:35], s3 offen sc1 lds
    s_waitcnt vmcnt(36)
    s_mov_b32 s3, 1310720
    s_add_u32 m0, s58, 5120
    s_nop 0
    buffer_load_dwordx4 v240, s[32:35], s3 offen sc1 lds
    buffer_load_dwordx4 v240, s[32:35], s3 offen offset:1024 sc1 lds
    buffer_load_dwordx4 v240, s[32:35], s3 offen offset:2048 sc1 lds
    buffer_load_dwordx4 v240, s[32:35], s3 offen offset:3072 sc1 lds
    s_add_u32 m0, s58, 9216
    s_nop 0
    buffer_load_dwordx4 v241, s[32:35], s3 offen sc1 lds
    s_mov_b32 s3, 1474560
    s_add_u32 m0, s58, 10240
    s_nop 0
    buffer_load_dwordx4 v240, s[32:35], s3 offen sc1 lds
    buffer_load_dwordx4 v240, s[32:35], s3 offen offset:1024 sc1 lds
    buffer_load_dwordx4 v240, s[32:35], s3 offen offset:2048 sc1 lds
    buffer_load_dwordx4 v240, s[32:35], s3 offen offset:3072 sc1 lds
    s_add_u32 m0, s58, 14336
    s_nop 0
    buffer_load_dwordx4 v241, s[32:35], s3 offen sc1 lds
    s_mov_b32 s3, 1638400
    s_add_u32 m0, s58, 15360
    s_nop 0
    buffer_load_dwordx4 v240, s[32:35], s3 offen sc1 lds
    buffer_load_dwordx4 v240, s[32:35], s3 offen offset:1024 sc1 lds
    buffer_load_dwordx4 v240, s[32:35], s3 offen offset:2048 sc1 lds
    buffer_load_dwordx4 v240, s[32:35], s3 offen offset:3072 sc1 lds
    s_add_u32 m0, s58, 19456
    s_nop 0
    buffer_load_dwordx4 v241, s[32:35], s3 offen sc1 lds
    s_mov_b32 s3, 1802240
    s_add_u32 m0, s58, 20480
    s_nop 0
    buffer_load_dwordx4 v240, s[32:35], s3 offen sc1 lds
    buffer_load_dwordx4 v240, s[32:35], s3 offen offset:1024 sc1 lds
    buffer_load_dwordx4 v240, s[32:35], s3 offen offset:2048 sc1 lds
    buffer_load_dwordx4 v240, s[32:35], s3 offen offset:3072 sc1 lds
    s_add_u32 m0, s58, 24576
    s_nop 0
    buffer_load_dwordx4 v241, s[32:35], s3 offen sc1 lds
    s_waitcnt vmcnt(36)
    s_mov_b32 s3, 1966080
    s_add_u32 m0, s58, 25600
    s_nop 0
    buffer_load_dwordx4 v240, s[32:35], s3 offen sc1 lds
    buffer_load_dwordx4 v240, s[32:35], s3 offen offset:1024 sc1 lds
    buffer_load_dwordx4 v240, s[32:35], s3 offen offset:2048 sc1 lds
    buffer_load_dwordx4 v240, s[32:35], s3 offen offset:3072 sc1 lds
    s_add_u32 m0, s58, 29696
    s_nop 0
    buffer_load_dwordx4 v241, s[32:35], s3 offen sc1 lds
    s_mov_b32 s3, 2129920
    s_add_u32 m0, s58, 30720
    s_nop 0
    buffer_load_dwordx4 v240, s[20:23], s3 offen sc1 lds
    buffer_load_dwordx4 v240, s[20:23], s3 offen offset:1024 sc1 lds
    buffer_load_dwordx4 v240, s[20:23], s3 offen offset:2048 sc1 lds
    buffer_load_dwordx4 v240, s[20:23], s3 offen offset:3072 sc1 lds
    s_add_u32 m0, s58, 34816
    s_nop 0
    buffer_load_dwordx4 v241, s[20:23], s3 offen sc1 lds
    s_mov_b32 s3, 2211840
    s_add_u32 m0, s58, 35840
    s_nop 0
    buffer_load_dwordx4 v240, s[32:35], s3 offen sc1 lds
    s_lshr_b32 s63, s95, 1
    s_lshr_b32 s62, s63, 1
    s_lshl_b32 s62, s62, 2
    s_bitcmp1_b32 s63, 0
    s_cselect_b32 s15, 128, 0
    s_add_u32 s62, s62, s15
    s_add_u32 s62, s62, 32
    s_cmp_lg_u32 s50, 0
    s_cbranch_scc1 L_h_hpoll_iss
    v_mov_b32 v2, s62
    global_load_dword v255, v2, s[48:49] sc1
L_h_hpoll_iss:
    buffer_load_dwordx4 v240, s[32:35], s3 offen offset:1024 sc1 lds
    buffer_load_dwordx4 v240, s[32:35], s3 offen offset:2048 sc1 lds
    buffer_load_dwordx4 v240, s[32:35], s3 offen offset:3072 sc1 lds
    s_add_u32 m0, s58, 39936
    s_nop 0
    buffer_load_dwordx4 v241, s[32:35], s3 offen sc1 lds
    v_lshrrev_b32 v3, 4, v1
    s_mul_i32 s61, s96, 160
    v_lshl_add_u32 v3, v3, 3, s61
    buffer_load_dwordx2 v[20:21], v3, s[36:39], 0 offen offset:0
    buffer_load_dwordx2 v[22:23], v3, s[36:39], 0 offen offset:32
    buffer_load_dwordx2 v[24:25], v3, s[36:39], 0 offen offset:64
    buffer_load_dwordx2 v[26:27], v3, s[36:39], 0 offen offset:96
    buffer_load_dwordx2 v[28:29], v3, s[36:39], 0 offen offset:128
    v_mov_b64 v[64:65], 0
    v_mov_b64 v[66:67], 0
    v_mov_b64 v[68:69], 0
    v_mov_b64 v[70:71], 0
    v_mov_b64 v[72:73], 0
    v_mov_b64 v[74:75], 0
    v_mov_b64 v[76:77], 0
    v_mov_b64 v[78:79], 0
    v_mov_b64 v[80:81], 0
    v_mov_b64 v[82:83], 0
    v_mov_b64 v[84:85], 0
    v_mov_b64 v[86:87], 0
    v_mov_b64 v[88:89], 0
    v_mov_b64 v[90:91], 0
    v_mov_b64 v[92:93], 0
    v_mov_b64 v[94:95], 0
    v_mov_b64 v[96:97], 0
    v_mov_b64 v[98:99], 0
    v_mov_b64 v[100:101], 0
    v_mov_b64 v[102:103], 0
    v_mov_b64 v[104:105], 0
    v_mov_b64 v[106:107], 0
    v_mov_b64 v[108:109], 0
    v_mov_b64 v[110:111], 0
    v_mov_b64 v[112:113], 0
    v_mov_b64 v[114:115], 0
    v_mov_b64 v[116:117], 0
    v_mov_b64 v[118:119], 0
    v_mov_b64 v[120:121], 0
    v_mov_b64 v[122:123], 0
    v_mov_b64 v[124:125], 0
    v_mov_b64 v[126:127], 0
    v_mov_b64 v[128:129], 0
    v_mov_b64 v[130:131], 0
    v_mov_b64 v[132:133], 0
    v_mov_b64 v[134:135], 0
    v_mov_b64 v[136:137], 0
    v_mov_b64 v[138:139], 0
    v_mov_b64 v[140:141], 0
    v_mov_b64 v[142:143], 0
    v_mov_b64 v[144:145], 0
    v_mov_b64 v[146:147], 0
    v_mov_b64 v[148:149], 0
    v_mov_b64 v[150:151], 0
    v_mov_b64 v[152:153], 0
    v_mov_b64 v[154:155], 0
    v_mov_b64 v[156:157], 0
    v_mov_b64 v[158:159], 0
    v_mov_b64 v[160:161], 0
    v_mov_b64 v[162:163], 0
    v_mov_b64 v[164:165], 0
    v_mov_b64 v[166:167], 0
    v_mov_b64 v[168:169], 0
    v_mov_b64 v[170:171], 0
    v_mov_b64 v[172:173], 0
    v_mov_b64 v[174:175], 0
    v_mov_b64 v[176:177], 0
    v_mov_b64 v[178:179], 0
    v_mov_b64 v[180:181], 0
    v_mov_b64 v[182:183], 0
    v_mov_b64 v[184:185], 0
    v_mov_b64 v[186:187], 0
    v_mov_b64 v[188:189], 0
    v_mov_b64 v[190:191], 0
    v_mov_b64 v[192:193], 0
    v_mov_b64 v[194:195], 0
    v_mov_b64 v[196:197], 0
    v_mov_b64 v[198:199], 0
    v_mov_b64 v[200:201], 0
    v_mov_b64 v[202:203], 0
    v_mov_b64 v[204:205], 0
    v_mov_b64 v[206:207], 0
    v_mov_b64 v[208:209], 0
    v_mov_b64 v[210:211], 0
    v_mov_b64 v[212:213], 0
    v_mov_b64 v[214:215], 0
    v_mov_b64 v[216:217], 0
    v_mov_b64 v[218:219], 0
    v_mov_b64 v[220:221], 0
    v_mov_b64 v[222:223], 0
    s_lshr_b32 s63, s95, 1
    s_lshr_b32 s62, s63, 1
    s_lshl_b32 s62, s62, 2
    s_bitcmp1_b32 s63, 0
    s_cselect_b32 s15, 128, 0
    s_add_u32 s62, s62, s15
    s_add_u32 s62, s62, 32
    s_cmp_lg_u32 s50, 0
    s_cbranch_scc1 L_p2_h_poll_skip
    s_waitcnt vmcnt(9)
    v_readfirstlane_b32 s61, v255
    s_nop 3
    s_cmp_ge_u32 s61, 8
    s_cbranch_scc1 L_p2_h_poll_skip
    v_mov_b32 v2, s62
    s_mov_b32 s15, 400000
L_p2_h_poll:
    global_load_dword v3, v2, s[48:49] sc1
    s_sub_u32 s15, s15, 1
    s_cbranch_scc1 L_p2_h_poll_out
    s_waitcnt vmcnt(0)
    v_readfirstlane_b32 s61, v3
    s_nop 3
    s_cmp_ge_u32 s61, 8
    s_cbranch_scc1 L_p2_h_poll_out
    s_sleep 1
    s_branch L_p2_h_poll
L_p2_h_poll_out:
L_p2_h_poll_skip:
    s_barrier
L_phase2:
    s_waitcnt vmcnt(40)
    s_mov_b32 s97, 0
    buffer_load_dwordx4 a[140:143], v244, s[28:31], s97 offen sc1
    buffer_load_dwordx4 a[144:147], v245, s[28:31], s97 offen sc1
    buffer_load_dwordx4 a[148:151], v246, s[28:31], s97 offen sc1
    buffer_load_dwordx4 a[152:155], v247, s[28:31], s97 offen sc1
    s_mov_b32 s97, 4096
    buffer_load_dwordx4 a[156:159], v244, s[28:31], s97 offen sc1
    buffer_load_dwordx4 a[160:163], v245, s[28:31], s97 offen sc1
    buffer_load_dwordx4 a[164:167], v246, s[28:31], s97 offen sc1
    buffer_load_dwordx4 a[168:171], v247, s[28:31], s97 offen sc1
    v_and_b32 v2, 15, v1
    v_lshrrev_b32 v3, 2, v2
    v_and_b32 v2, 3, v2
    v_lshlrev_b32 v2, 6, v2
    v_lshl_add_u32 v2, v3, 8, v2
    s_lshl_b32 s61, s95, 12
    v_add_u32 v52, s61, v2
    v_lshlrev_b32 v2, 3, v1
    v_sub_u32 v60, v244, v2
    v_sub_u32 v61, v245, v2
    v_sub_u32 v62, v246, v2
    v_sub_u32 v63, v247, v2
    s_waitcnt vmcnt(4)
    v_mfma_f32_16x16x32_bf16 v[64:67], a[0:3], a[140:143], v[64:67]
    s_mov_b32 s97, 8192
    v_mfma_f32_16x16x32_bf16 v[84:87], a[0:3], a[144:147], v[84:87]
    buffer_load_dwordx4 a[172:175], v244, s[28:31], s97 offen sc1
    v_mfma_f32_16x16x32_bf16 v[104:107], a[0:3], a[148:151], v[104:107]
    buffer_load_dwordx4 a[176:179], v245, s[28:31], s97 offen sc1
    v_mfma_f32_16x16x32_bf16 v[124:127], a[0:3], a[152:155], v[124:127]
    v_mfma_f32_16x16x32_bf16 v[68:71], a[4:7], a[140:143], v[68:71]
    buffer_load_dwordx4 a[180:183], v246, s[28:31], s97 offen sc1
    v_mfma_f32_16x16x32_bf16 v[88:91], a[4:7], a[144:147], v[88:91]
    buffer_load_dwordx4 a[184:187], v247, s[28:31], s97 offen sc1
    v_mfma_f32_16x16x32_bf16 v[108:111], a[4:7], a[148:151], v[108:111]
    s_mov_b32 s97, 12288
    v_mfma_f32_16x16x32_bf16 v[128:131], a[4:7], a[152:155], v[128:131]
    buffer_load_dwordx4 a[188:191], v244, s[28:31], s97 offen sc1
    v_mfma_f32_16x16x32_bf16 v[72:75], a[8:11], a[140:143], v[72:75]
    buffer_load_dwordx4 a[192:195], v245, s[28:31], s97 offen sc1
    v_mfma_f32_16x16x32_bf16 v[92:95], a[8:11], a[144:147], v[92:95]
    v_mfma_f32_16x16x32_bf16 v[112:115], a[8:11], a[148:151], v[112:115]
    buffer_load_dwordx4 a[196:199], v246, s[28:31], s97 offen sc1
    v_mfma_f32_16x16x32_bf16 v[132:135], a[8:11], a[152:155], v[132:135]
    buffer_load_dwordx4 a[200:203], v247, s[28:31], s97 offen sc1
    v_mfma_f32_16x16x32_bf16 v[76:79], a[12:15], a[140:143], v[76:79]
    s_mov_b32 s97, 16384
    v_mfma_f32_16x16x32_bf16 v[96:99], a[12:15], a[144:147], v[96:99]
    buffer_load_dwordx4 a[204:207], v244, s[28:31], s97 offen sc1
    v_mfma_f32_16x16x32_bf16 v[116:119], a[12:15], a[148:151], v[116:119]
    buffer_load_dwordx4 a[208:211], v245, s[28:31], s97 offen sc1
    v_mfma_f32_16x16x32_bf16 v[136:139], a[12:15], a[152:155], v[136:139]
    v_mfma_f32_16x16x32_bf16 v[80:83], a[16:19], a[140:143], v[80:83]
    buffer_load_dwordx4 a[212:215], v246, s[28:31], s97 offen sc1
    v_mfma_f32_16x16x32_bf16 v[100:103], a[16:19], a[144:147], v[100:103]
    buffer_load_dwordx4 a[216:219], v247, s[28:31], s97 offen sc1
    v_mfma_f32_16x16x32_bf16 v[120:123], a[16:19], a[148:151], v[120:123]
    v_mfma_f32_16x16x32_bf16 v[140:143], a[16:19], a[152:155], v[140:143]
    s_waitcnt vmcnt(12)
    v_mfma_f32_16x16x32_bf16 v[64:67], a[20:23], a[156:159], v[64:67]
    s_mov_b32 s97, 20480
    v_mfma_f32_16x16x32_bf16 v[84:87], a[20:23], a[160:163], v[84:87]
    buffer_load_dwordx4 a[140:143], v244, s[28:31], s97 offen sc1
    v_mfma_f32_16x16x32_bf16 v[104:107], a[20:23], a[164:167], v[104:107]
    ds_read_b128 a[0:3], v242 offset:0
    v_mfma_f32_16x16x32_bf16 v[124:127], a[20:23], a[168:171], v[124:127]
    v_mfma_f32_16x16x32_bf16 v[68:71], a[24:27], a[156:159], v[68:71]
    v_mfma_f32_16x16x32_bf16 v[88:91], a[24:27], a[160:163], v[88:91]
    buffer_load_dwordx4 a[144:147], v245, s[28:31], s97 offen sc1
    v_mfma_f32_16x16x32_bf16 v[108:111], a[24:27], a[164:167], v[108:111]
    ds_read_b128 a[4:7], v242 offset:1024
    v_mfma_f32_16x16x32_bf16 v[128:131], a[24:27], a[168:171], v[128:131]
    v_mfma_f32_16x16x32_bf16 v[72:75], a[28:31], a[156:159], v[72:75]
    ds_read_b128 a[8:11], v242 offset:2048
    v_mfma_f32_16x16x32_bf16 v[92:95], a[28:31], a[160:163], v[92:95]
    v_mfma_f32_16x16x32_bf16 v[112:115], a[28:31], a[164:167], v[112:115]
    buffer_load_dwordx4 a[148:151], v246, s[28:31], s97 offen sc1
    v_mfma_f32_16x16x32_bf16 v[132:135], a[28:31], a[168:171], v[132:135]
    ds_read_b128 a[12:15], v242 offset:3072
    v_mfma_f32_16x16x32_bf16 v[76:79], a[32:35], a[156:159], v[76:79]
    v_mfma_f32_16x16x32_bf16 v[96:99], a[32:35], a[160:163], v[96:99]
    v_mfma_f32_16x16x32_bf16 v[116:119], a[32:35], a[164:167], v[116:119]
    buffer_load_dwordx4 a[152:155], v247, s[28:31], s97 offen sc1
    v_mfma_f32_16x16x32_bf16 v[136:139], a[32:35], a[168:171], v[136:139]
    ds_read_b128 a[16:19], v242 offset:4096
    v_mfma_f32_16x16x32_bf16 v[80:83], a[36:39], a[156:159], v[80:83]
    v_mfma_f32_16x16x32_bf16 v[100:103], a[36:39], a[160:163], v[100:103]
    v_mfma_f32_16x16x32_bf16 v[120:123], a[36:39], a[164:167], v[120:123]
    v_mfma_f32_16x16x32_bf16 v[140:143], a[36:39], a[168:171], v[140:143]
    s_waitcnt vmcnt(12) lgkmcnt(0)
    v_mfma_f32_16x16x32_bf16 v[64:67], a[40:43], a[172:175], v[64:67]
    s_mov_b32 s97, 24576
    v_mfma_f32_16x16x32_bf16 v[84:87], a[40:43], a[176:179], v[84:87]
    buffer_load_dwordx4 a[156:159], v244, s[28:31], s97 offen sc1
    v_mfma_f32_16x16x32_bf16 v[104:107], a[40:43], a[180:183], v[104:107]
    ds_read_b128 a[20:23], v242 offset:5120
    v_mfma_f32_16x16x32_bf16 v[124:127], a[40:43], a[184:187], v[124:127]
    buffer_load_dwordx4 a[160:163], v245, s[28:31], s97 offen sc1
    v_mfma_f32_16x16x32_bf16 v[68:71], a[44:47], a[172:175], v[68:71]
    v_mfma_f32_16x16x32_bf16 v[88:91], a[44:47], a[176:179], v[88:91]
    buffer_load_dwordx4 a[164:167], v246, s[28:31], s97 offen sc1
    v_mfma_f32_16x16x32_bf16 v[108:111], a[44:47], a[180:183], v[108:111]
    ds_read_b128 a[24:27], v242 offset:6144
    v_mfma_f32_16x16x32_bf16 v[128:131], a[44:47], a[184:187], v[128:131]
    buffer_load_dwordx4 a[168:171], v247, s[28:31], s97 offen sc1
    v_mfma_f32_16x16x32_bf16 v[72:75], a[48:51], a[172:175], v[72:75]
    ds_read_b128 a[28:31], v242 offset:7168
    v_mfma_f32_16x16x32_bf16 v[92:95], a[48:51], a[176:179], v[92:95]
    v_mfma_f32_16x16x32_bf16 v[112:115], a[48:51], a[180:183], v[112:115]
    buffer_load_dword v16, v52, s[24:27], 0 offen offset:0 sc1
    v_mfma_f32_16x16x32_bf16 v[132:135], a[48:51], a[184:187], v[132:135]
    ds_read_b128 a[32:35], v242 offset:8192
    v_mfma_f32_16x16x32_bf16 v[76:79], a[52:55], a[172:175], v[76:79]
    buffer_load_dword v17, v52, s[24:27], 0 offen offset:1024 sc1
    v_mfma_f32_16x16x32_bf16 v[96:99], a[52:55], a[176:179], v[96:99]
    v_mfma_f32_16x16x32_bf16 v[116:119], a[52:55], a[180:183], v[116:119]
    buffer_load_dword v18, v52, s[24:27], 0 offen offset:2048 sc1
    v_mfma_f32_16x16x32_bf16 v[136:139], a[52:55], a[184:187], v[136:139]
    ds_read_b128 a[36:39], v242 offset:9216
    v_mfma_f32_16x16x32_bf16 v[80:83], a[56:59], a[172:175], v[80:83]
    buffer_load_dword v19, v52, s[24:27], 0 offen offset:3072 sc1
    v_mfma_f32_16x16x32_bf16 v[100:103], a[56:59], a[176:179], v[100:103]
    v_mfma_f32_16x16x32_bf16 v[120:123], a[56:59], a[180:183], v[120:123]
    v_mfma_f32_16x16x32_bf16 v[140:143], a[56:59], a[184:187], v[140:143]
    s_waitcnt vmcnt(16) lgkmcnt(0)
    s_cmp_lg_u32 s60, 0
    s_cbranch_scc1 L_p2_nosig
    s_barrier
    s_lshr_b32 s61, s51, 1
    s_lshl_b32 s61, s61, 2
    s_bitcmp1_b32 s51, 0
    s_cselect_b32 s15, 128, 0
    s_add_u32 s61, s61, s15
    s_add_u32 s61, s61, 64
    s_cmp_lg_u32 s50, 0
    s_cbranch_scc1 L_q_sig
    v_mov_b32 v2, s61
    v_mov_b32 v3, 1
    s_mov_b64 exec, 1
    global_atomic_add v2, v3, s[48:49] sc1
    s_mov_b64 exec, -1
L_q_sig:
L_p2_nosig:
    v_mfma_f32_16x16x32_bf16 v[64:67], a[60:63], a[188:191], v[64:67]
    s_mov_b32 s97, 28672
    v_mfma_f32_16x16x32_bf16 v[84:87], a[60:63], a[192:195], v[84:87]
    buffer_load_dwordx4 a[172:175], v244, s[28:31], s97 offen sc1
    v_mfma_f32_16x16x32_bf16 v[104:107], a[60:63], a[196:199], v[104:107]
    ds_read_b128 a[40:43], v242 offset:10240
    v_mfma_f32_16x16x32_bf16 v[124:127], a[60:63], a[200:203], v[124:127]
    v_mfma_f32_16x16x32_bf16 v[68:71], a[64:67], a[188:191], v[68:71]
    v_mfma_f32_16x16x32_bf16 v[88:91], a[64:67], a[192:195], v[88:91]
    buffer_load_dwordx4 a[176:179], v245, s[28:31], s97 offen sc1
    v_mfma_f32_16x16x32_bf16 v[108:111], a[64:67], a[196:199], v[108:111]
    ds_read_b128 a[44:47], v242 offset:11264
    v_mfma_f32_16x16x32_bf16 v[128:131], a[64:67], a[200:203], v[128:131]
    v_mfma_f32_16x16x32_bf16 v[72:75], a[68:71], a[188:191], v[72:75]
    ds_read_b128 a[48:51], v242 offset:12288
    v_mfma_f32_16x16x32_bf16 v[92:95], a[68:71], a[192:195], v[92:95]
    v_mfma_f32_16x16x32_bf16 v[112:115], a[68:71], a[196:199], v[112:115]
    buffer_load_dwordx4 a[180:183], v246, s[28:31], s97 offen sc1
    v_mfma_f32_16x16x32_bf16 v[132:135], a[68:71], a[200:203], v[132:135]
    ds_read_b128 a[52:55], v242 offset:13312
    v_mfma_f32_16x16x32_bf16 v[76:79], a[72:75], a[188:191], v[76:79]
    v_mfma_f32_16x16x32_bf16 v[96:99], a[72:75], a[192:195], v[96:99]
    v_mfma_f32_16x16x32_bf16 v[116:119], a[72:75], a[196:199], v[116:119]
    buffer_load_dwordx4 a[184:187], v247, s[28:31], s97 offen sc1
    v_mfma_f32_16x16x32_bf16 v[136:139], a[72:75], a[200:203], v[136:139]
    ds_read_b128 a[56:59], v242 offset:14336
    v_mfma_f32_16x16x32_bf16 v[80:83], a[76:79], a[188:191], v[80:83]
    v_mfma_f32_16x16x32_bf16 v[100:103], a[76:79], a[192:195], v[100:103]
    v_mfma_f32_16x16x32_bf16 v[120:123], a[76:79], a[196:199], v[120:123]
    v_mfma_f32_16x16x32_bf16 v[140:143], a[76:79], a[200:203], v[140:143]
    s_waitcnt vmcnt(16) lgkmcnt(0)
    v_mfma_f32_16x16x32_bf16 v[64:67], a[80:83], a[204:207], v[64:67]
    s_mov_b32 s97, 32768
    v_mfma_f32_16x16x32_bf16 v[84:87], a[80:83], a[208:211], v[84:87]
    buffer_load_dwordx4 a[188:191], v244, s[28:31], s97 offen sc1
    v_mfma_f32_16x16x32_bf16 v[104:107], a[80:83], a[212:215], v[104:107]
    ds_read_b128 a[60:63], v242 offset:15360
    v_mfma_f32_16x16x32_bf16 v[124:127], a[80:83], a[216:219], v[124:127]
    v_mfma_f32_16x16x32_bf16 v[68:71], a[84:87], a[204:207], v[68:71]
    v_mfma_f32_16x16x32_bf16 v[88:91], a[84:87], a[208:211], v[88:91]
    buffer_load_dwordx4 a[192:195], v245, s[28:31], s97 offen sc1
    v_mfma_f32_16x16x32_bf16 v[108:111], a[84:87], a[212:215], v[108:111]
    ds_read_b128 a[64:67], v242 offset:16384
    v_mfma_f32_16x16x32_bf16 v[128:131], a[84:87], a[216:219], v[128:131]
    v_mfma_f32_16x16x32_bf16 v[72:75], a[88:91], a[204:207], v[72:75]
    ds_read_b128 a[68:71], v242 offset:17408
    v_mfma_f32_16x16x32_bf16 v[92:95], a[88:91], a[208:211], v[92:95]
    v_mfma_f32_16x16x32_bf16 v[112:115], a[88:91], a[212:215], v[112:115]
    buffer_load_dwordx4 a[196:199], v246, s[28:31], s97 offen sc1
    v_mfma_f32_16x16x32_bf16 v[132:135], a[88:91], a[216:219], v[132:135]
    ds_read_b128 a[72:75], v242 offset:18432
    v_mfma_f32_16x16x32_bf16 v[76:79], a[92:95], a[204:207], v[76:79]
    v_mfma_f32_16x16x32_bf16 v[96:99], a[92:95], a[208:211], v[96:99]
    v_mfma_f32_16x16x32_bf16 v[116:119], a[92:95], a[212:215], v[116:119]
    buffer_load_dwordx4 a[200:203], v247, s[28:31], s97 offen sc1
    v_mfma_f32_16x16x32_bf16 v[136:139], a[92:95], a[216:219], v[136:139]
    ds_read_b128 a[76:79], v242 offset:19456
    v_mfma_f32_16x16x32_bf16 v[80:83], a[96:99], a[204:207], v[80:83]
    v_mfma_f32_16x16x32_bf16 v[100:103], a[96:99], a[208:211], v[100:103]
    v_mfma_f32_16x16x32_bf16 v[120:123], a[96:99], a[212:215], v[120:123]
    v_mfma_f32_16x16x32_bf16 v[140:143], a[96:99], a[216:219], v[140:143]
    s_waitcnt vmcnt(16) lgkmcnt(0)
    v_mfma_f32_16x16x32_bf16 v[64:67], a[100:103], a[140:143], v[64:67]
    s_mov_b32 s97, 36864
    v_mfma_f32_16x16x32_bf16 v[84:87], a[100:103], a[144:147], v[84:87]
    buffer_load_dwordx4 a[204:207], v244, s[28:31], s97 offen sc1
    v_mfma_f32_16x16x32_bf16 v[104:107], a[100:103], a[148:151], v[104:107]
    ds_read_b128 a[80:83], v242 offset:20480
    v_mfma_f32_16x16x32_bf16 v[124:127], a[100:103], a[152:155], v[124:127]
    v_mfma_f32_16x16x32_bf16 v[68:71], a[104:107], a[140:143], v[68:71]
    v_mfma_f32_16x16x32_bf16 v[88:91], a[104:107], a[144:147], v[88:91]
    buffer_load_dwordx4 a[208:211], v245, s[28:31], s97 offen sc1
    v_mfma_f32_16x16x32_bf16 v[108:111], a[104:107], a[148:151], v[108:111]
    ds_read_b128 a[84:87], v242 offset:21504
    v_mfma_f32_16x16x32_bf16 v[128:131], a[104:107], a[152:155], v[128:131]
    v_mfma_f32_16x16x32_bf16 v[72:75], a[108:111], a[140:143], v[72:75]
    ds_read_b128 a[88:91], v242 offset:22528
    v_mfma_f32_16x16x32_bf16 v[92:95], a[108:111], a[144:147], v[92:95]
    v_mfma_f32_16x16x32_bf16 v[112:115], a[108:111], a[148:151], v[112:115]
    buffer_load_dwordx4 a[212:215], v246, s[28:31], s97 offen sc1
    v_mfma_f32_16x16x32_bf16 v[132:135], a[108:111], a[152:155], v[132:135]
    ds_read_b128 a[92:95], v242 offset:23552
    v_mfma_f32_16x16x32_bf16 v[76:79], a[112:115], a[140:143], v[76:79]
    v_mfma_f32_16x16x32_bf16 v[96:99], a[112:115], a[144:147], v[96:99]
    v_mfma_f32_16x16x32_bf16 v[116:119], a[112:115], a[148:151], v[116:119]
    buffer_load_dwordx4 a[216:219], v247, s[28:31], s97 offen sc1
    v_mfma_f32_16x16x32_bf16 v[136:139], a[112:115], a[152:155], v[136:139]
    ds_read_b128 a[96:99], v242 offset:24576
    v_mfma_f32_16x16x32_bf16 v[80:83], a[116:119], a[140:143], v[80:83]
    v_mfma_f32_16x16x32_bf16 v[100:103], a[116:119], a[144:147], v[100:103]
    v_mfma_f32_16x16x32_bf16 v[120:123], a[116:119], a[148:151], v[120:123]
    v_mfma_f32_16x16x32_bf16 v[140:143], a[116:119], a[152:155], v[140:143]
    s_waitcnt vmcnt(16) lgkmcnt(0)
    s_lshr_b32 s63, s95, 1
    s_lshr_b32 s62, s63, 1
    s_lshl_b32 s62, s62, 2
    s_bitcmp1_b32 s63, 0
    s_cselect_b32 s15, 128, 0
    s_add_u32 s62, s62, s15
    s_add_u32 s62, s62, 64
    v_mov_b32 v2, s62
    v_mfma_f32_16x16x32_bf16 v[64:67], a[120:123], a[156:159], v[64:67]
    s_mov_b32 s97, 40960
    v_mfma_f32_16x16x32_bf16 v[84:87], a[120:123], a[160:163], v[84:87]
    buffer_load_dwordx4 a[140:143], v244, s[28:31], s97 offen sc1
    v_mfma_f32_16x16x32_bf16 v[104:107], a[120:123], a[164:167], v[104:107]
    ds_read_b128 a[100:103], v242 offset:25600
    v_mfma_f32_16x16x32_bf16 v[124:127], a[120:123], a[168:171], v[124:127]
    v_mfma_f32_16x16x32_bf16 v[68:71], a[124:127], a[156:159], v[68:71]
    buffer_load_dwordx4 a[144:147], v245, s[28:31], s97 offen sc1
    v_mfma_f32_16x16x32_bf16 v[88:91], a[124:127], a[160:163], v[88:91]
    ds_read_b128 a[104:107], v242 offset:26624
    v_mfma_f32_16x16x32_bf16 v[108:111], a[124:127], a[164:167], v[108:111]
    v_mfma_f32_16x16x32_bf16 v[128:131], a[124:127], a[168:171], v[128:131]
    v_mfma_f32_16x16x32_bf16 v[72:75], a[128:131], a[156:159], v[72:75]
    buffer_load_dwordx4 a[148:151], v246, s[28:31], s97 offen sc1
    v_mfma_f32_16x16x32_bf16 v[92:95], a[128:131], a[160:163], v[92:95]
    ds_read_b128 a[108:111], v242 offset:27648
    v_mfma_f32_16x16x32_bf16 v[112:115], a[128:131], a[164:167], v[112:115]
    v_mfma_f32_16x16x32_bf16 v[132:135], a[128:131], a[168:171], v[132:135]
    buffer_load_dwordx4 a[152:155], v247, s[28:31], s97 offen sc1
    v_mfma_f32_16x16x32_bf16 v[76:79], a[132:135], a[156:159], v[76:79]
    ds_read_b128 a[112:115], v242 offset:28672
    v_mfma_f32_16x16x32_bf16 v[96:99], a[132:135], a[160:163], v[96:99]
    v_mfma_f32_16x16x32_bf16 v[116:119], a[132:135], a[164:167], v[116:119]
    ds_read_b128 a[116:119], v242 offset:29696
    v_mfma_f32_16x16x32_bf16 v[136:139], a[132:135], a[168:171], v[136:139]
    global_load_dword v50, v2, s[48:49] sc1
    v_mfma_f32_16x16x32_bf16 v[80:83], a[136:139], a[156:159], v[80:83]
    v_mfma_f32_16x16x32_bf16 v[100:103], a[136:139], a[160:163], v[100:103]
    v_mfma_f32_16x16x32_bf16 v[120:123], a[136:139], a[164:167], v[120:123]
    v_mfma_f32_16x16x32_bf16 v[140:143], a[136:139], a[168:171], v[140:143]
    s_waitcnt vmcnt(13) lgkmcnt(0)
    v_mfma_f32_16x16x32_bf16 v[64:67], a[0:3], a[172:175], v[64:67]
    s_mov_b32 s97, 45056
    v_mfma_f32_16x16x32_bf16 v[84:87], a[0:3], a[176:179], v[84:87]
    buffer_load_dwordx4 a[156:159], v244, s[28:31], s97 offen sc1
    v_mfma_f32_16x16x32_bf16 v[104:107], a[0:3], a[180:183], v[104:107]
    ds_read_b128 a[120:123], v242 offset:30720
    v_mfma_f32_16x16x32_bf16 v[124:127], a[0:3], a[184:187], v[124:127]
    v_mfma_f32_16x16x32_bf16 v[68:71], a[4:7], a[172:175], v[68:71]
    v_mfma_f32_16x16x32_bf16 v[88:91], a[4:7], a[176:179], v[88:91]
    buffer_load_dwordx4 a[160:163], v245, s[28:31], s97 offen sc1
    v_mfma_f32_16x16x32_bf16 v[108:111], a[4:7], a[180:183], v[108:111]
    ds_read_b128 a[124:127], v242 offset:31744
    v_mfma_f32_16x16x32_bf16 v[128:131], a[4:7], a[184:187], v[128:131]
    v_mfma_f32_16x16x32_bf16 v[72:75], a[8:11], a[172:175], v[72:75]
    ds_read_b128 a[128:131], v242 offset:32768
    v_mfma_f32_16x16x32_bf16 v[92:95], a[8:11], a[176:179], v[92:95]
    v_mfma_f32_16x16x32_bf16 v[112:115], a[8:11], a[180:183], v[112:115]
    buffer_load_dwordx4 a[164:167], v246, s[28:31], s97 offen sc1
    v_mfma_f32_16x16x32_bf16 v[132:135], a[8:11], a[184:187], v[132:135]
    ds_read_b128 a[132:135], v242 offset:33792
    v_mfma_f32_16x16x32_bf16 v[76:79], a[12:15], a[172:175], v[76:79]
    v_mfma_f32_16x16x32_bf16 v[96:99], a[12:15], a[176:179], v[96:99]
    v_mfma_f32_16x16x32_bf16 v[116:119], a[12:15], a[180:183], v[116:119]
    buffer_load_dwordx4 a[168:171], v247, s[28:31], s97 offen sc1
    v_mfma_f32_16x16x32_bf16 v[136:139], a[12:15], a[184:187], v[136:139]
    ds_read_b128 a[136:139], v242 offset:34816
    v_mfma_f32_16x16x32_bf16 v[80:83], a[16:19], a[172:175], v[80:83]
    v_mfma_f32_16x16x32_bf16 v[100:103], a[16:19], a[176:179], v[100:103]
    v_mfma_f32_16x16x32_bf16 v[120:123], a[16:19], a[180:183], v[120:123]
    v_mfma_f32_16x16x32_bf16 v[140:143], a[16:19], a[184:187], v[140:143]
    s_waitcnt vmcnt(13) lgkmcnt(0)
    v_mfma_f32_16x16x32_bf16 v[64:67], a[20:23], a[188:191], v[64:67]
    s_mov_b32 s97, 49152
    v_mfma_f32_16x16x32_bf16 v[84:87], a[20:23], a[192:195], v[84:87]
    buffer_load_dwordx4 a[172:175], v244, s[28:31], s97 offen sc1
    v_mfma_f32_16x16x32_bf16 v[104:107], a[20:23], a[196:199], v[104:107]
    ds_read_b128 a[0:3], v242 offset:35840
    s_mul_i32 s68, s50, 5120
    v_mfma_f32_16x16x32_bf16 v[124:127], a[20:23], a[200:203], v[124:127]
    v_lshl_add_u32 v224, v1, 4, s68
    v_mfma_f32_16x16x32_bf16 v[68:71], a[24:27], a[188:191], v[68:71]
    v_add_u32 v225, 40960, v224
    v_mfma_f32_16x16x32_bf16 v[88:91], a[24:27], a[192:195], v[88:91]
    buffer_load_dwordx4 a[176:179], v245, s[28:31], s97 offen sc1
    s_mul_i32 s68, s50, 20480
    v_mfma_f32_16x16x32_bf16 v[108:111], a[24:27], a[196:199], v[108:111]
    ds_read_b128 a[4:7], v242 offset:36864
    v_lshl_add_u32 v13, v1, 4, s68
    v_mfma_f32_16x16x32_bf16 v[128:131], a[24:27], a[200:203], v[128:131]
    s_add_u32 s69, s50, 1
    v_mfma_f32_16x16x32_bf16 v[72:75], a[28:31], a[188:191], v[72:75]
    ds_read_b128 a[8:11], v242 offset:37888
    s_and_b32 s69, s69, 3
    v_mfma_f32_16x16x32_bf16 v[92:95], a[28:31], a[192:195], v[92:95]
    s_mul_i32 s69, s69, 5120
    v_mfma_f32_16x16x32_bf16 v[112:115], a[28:31], a[196:199], v[112:115]
    buffer_load_dwordx4 a[180:183], v246, s[28:31], s97 offen sc1
    v_add_u32 v226, s69, v13
    v_mfma_f32_16x16x32_bf16 v[132:135], a[28:31], a[200:203], v[132:135]
    ds_read_b128 a[12:15], v242 offset:38912
    s_add_u32 s69, s50, 2
    v_mfma_f32_16x16x32_bf16 v[76:79], a[32:35], a[188:191], v[76:79]
    s_and_b32 s69, s69, 3
    v_mfma_f32_16x16x32_bf16 v[96:99], a[32:35], a[192:195], v[96:99]
    s_mul_i32 s69, s69, 5120
    v_mfma_f32_16x16x32_bf16 v[116:119], a[32:35], a[196:199], v[116:119]
    buffer_load_dwordx4 a[184:187], v247, s[28:31], s97 offen sc1
    v_add_u32 v227, s69, v13
    v_mfma_f32_16x16x32_bf16 v[136:139], a[32:35], a[200:203], v[136:139]
    ds_read_b128 a[16:19], v242 offset:39936
    s_add_u32 s69, s50, 3
    v_mfma_f32_16x16x32_bf16 v[80:83], a[36:39], a[188:191], v[80:83]
    s_and_b32 s69, s69, 3
    v_mfma_f32_16x16x32_bf16 v[100:103], a[36:39], a[192:195], v[100:103]
    s_mul_i32 s69, s69, 5120
    v_mfma_f32_16x16x32_bf16 v[120:123], a[36:39], a[196:199], v[120:123]
    v_add_u32 v228, s69, v13
    v_mfma_f32_16x16x32_bf16 v[140:143], a[36:39], a[200:203], v[140:143]
    s_waitcnt vmcnt(13) lgkmcnt(0)
    v_mfma_f32_16x16x32_bf16 v[64:67], a[40:43], a[204:207], v[64:67]
    s_mov_b32 s97, 53248
    v_mfma_f32_16x16x32_bf16 v[84:87], a[40:43], a[208:211], v[84:87]
    buffer_load_dwordx4 a[188:191], v244, s[16:19], s97 offen sc1
    v_mfma_f32_16x16x32_bf16 v[104:107], a[40:43], a[212:215], v[104:107]
    s_mul_i32 s68, s50, 2816
    v_mfma_f32_16x16x32_bf16 v[124:127], a[40:43], a[216:219], v[124:127]
    buffer_load_dwordx4 a[192:195], v245, s[16:19], s97 offen sc1
    s_add_u32 s68, s68, 81920
    v_mfma_f32_16x16x32_bf16 v[68:71], a[44:47], a[204:207], v[68:71]
    v_and_b32 v13, 15, v1
    v_mfma_f32_16x16x32_bf16 v[88:91], a[44:47], a[208:211], v[88:91]
    buffer_load_dwordx4 a[196:199], v246, s[16:19], s97 offen sc1
    v_mul_u32_u24 v13, 176, v13
    v_mfma_f32_16x16x32_bf16 v[108:111], a[44:47], a[212:215], v[108:111]
    v_lshrrev_b32 v15, 4, v1
    v_mfma_f32_16x16x32_bf16 v[128:131], a[44:47], a[216:219], v[128:131]
    buffer_load_dwordx4 a[200:203], v247, s[16:19], s97 offen sc1
    v_lshl_add_u32 v13, v15, 3, v13
    v_mfma_f32_16x16x32_bf16 v[72:75], a[48:51], a[204:207], v[72:75]
    s_mov_b32 s3, 2375680
    v_add_u32 v229, s68, v13
    v_mfma_f32_16x16x32_bf16 v[92:95], a[48:51], a[208:211], v[92:95]
    buffer_load_dwordx4 a[20:23], v240, s[32:35], s3 offen sc1
    s_lshl_b32 s69, s95, 6
    v_mfma_f32_16x16x32_bf16 v[112:115], a[48:51], a[212:215], v[112:115]
    s_lshl_b32 s70, s50, 4
    v_mfma_f32_16x16x32_bf16 v[132:135], a[48:51], a[216:219], v[132:135]
    buffer_load_dwordx4 a[24:27], v240, s[32:35], s3 offen offset:1024 sc1
    s_add_u32 s69, s69, s70
    v_mfma_f32_16x16x32_bf16 v[76:79], a[52:55], a[204:207], v[76:79]
    s_mul_i32 s69, s69, 1280
    v_mfma_f32_16x16x32_bf16 v[96:99], a[52:55], a[208:211], v[96:99]
    buffer_load_dwordx4 a[28:31], v240, s[32:35], s3 offen offset:2048 sc1
    s_mul_i32 s70, s96, 160
    v_mfma_f32_16x16x32_bf16 v[116:119], a[52:55], a[212:215], v[116:119]
    s_add_u32 s69, s69, s70
    v_mfma_f32_16x16x32_bf16 v[136:139], a[52:55], a[216:219], v[136:139]
    buffer_load_dwordx4 a[32:35], v240, s[32:35], s3 offen offset:3072 sc1
    v_add_u32 v13, 0, v1
    v_mfma_f32_16x16x32_bf16 v[80:83], a[56:59], a[204:207], v[80:83]
    v_mul_u32_u24 v15, 6554, v13
    v_mfma_f32_16x16x32_bf16 v[100:103], a[56:59], a[208:211], v[100:103]
    buffer_load_dwordx4 a[36:39], v241, s[32:35], s3 offen sc1
    v_lshrrev_b32 v15, 16, v15
    v_mfma_f32_16x16x32_bf16 v[120:123], a[56:59], a[212:215], v[120:123]
    v_mul_u32_u24 v12, 10, v15
    v_mfma_f32_16x16x32_bf16 v[140:143], a[56:59], a[216:219], v[140:143]
    s_waitcnt vmcnt(17)
    v_readfirstlane_b32 s61, v50
    s_nop 3
    s_cmp_ge_u32 s61, 8
    s_cbranch_scc1 L_p2_o_ready
    s_lshr_b32 s63, s95, 1
    s_lshr_b32 s62, s63, 1
    s_lshl_b32 s62, s62, 2
    s_bitcmp1_b32 s63, 0
    s_cselect_b32 s15, 128, 0
    s_add_u32 s62, s62, s15
    s_add_u32 s62, s62, 64
    v_mov_b32 v2, s62
    s_mov_b32 s15, 400000
L_p2_o_poll:
    global_load_dword v3, v2, s[48:49] sc1
    s_sub_u32 s15, s15, 1
    s_cbranch_scc1 L_p2_o_poll_out
    s_waitcnt vmcnt(0)
    v_readfirstlane_b32 s61, v3
    s_nop 3
    s_cmp_ge_u32 s61, 8
    s_cbranch_scc1 L_p2_o_poll_out
    s_sleep 1
    s_branch L_p2_o_poll
L_p2_o_poll_out:
L_p2_o_ready:
    v_mfma_f32_16x16x32_bf16 v[64:67], a[60:63], a[140:143], v[64:67]
    s_mov_b32 s97, 55296
    v_mfma_f32_16x16x32_bf16 v[84:87], a[60:63], a[144:147], v[84:87]
    buffer_load_dwordx4 a[204:207], v244, s[28:31], s97 offen sc1
    v_mfma_f32_16x16x32_bf16 v[104:107], a[60:63], a[148:151], v[104:107]
    v_sub_u32 v12, v13, v12
    v_mfma_f32_16x16x32_bf16 v[124:127], a[60:63], a[152:155], v[124:127]
    buffer_load_dwordx4 a[208:211], v245, s[28:31], s97 offen sc1
    v_mul_u32_u24 v230, 176, v15
    v_mfma_f32_16x16x32_bf16 v[68:71], a[64:67], a[140:143], v[68:71]
    v_lshl_add_u32 v230, v12, 4, v230
    v_mfma_f32_16x16x32_bf16 v[88:91], a[64:67], a[144:147], v[88:91]
    buffer_load_dwordx4 a[212:215], v246, s[28:31], s97 offen sc1
    v_add_u32 v230, s68, v230
    v_mfma_f32_16x16x32_bf16 v[108:111], a[64:67], a[148:151], v[108:111]
    v_mul_u32_u24 v15, 1280, v15
    v_mfma_f32_16x16x32_bf16 v[128:131], a[64:67], a[152:155], v[128:131]
    buffer_load_dwordx4 a[216:219], v247, s[28:31], s97 offen sc1
    v_lshl_add_u32 v15, v12, 4, v15
    v_mfma_f32_16x16x32_bf16 v[72:75], a[68:71], a[140:143], v[72:75]
    s_mov_b32 s3, 2539520
    v_add_u32 v233, s69, v15
    v_mfma_f32_16x16x32_bf16 v[92:95], a[68:71], a[144:147], v[92:95]
    buffer_load_dwordx4 a[40:43], v240, s[32:35], s3 offen sc1
    v_add_u32 v13, 64, v1
    v_mfma_f32_16x16x32_bf16 v[112:115], a[68:71], a[148:151], v[112:115]
    v_mul_u32_u24 v15, 6554, v13
    v_mfma_f32_16x16x32_bf16 v[132:135], a[68:71], a[152:155], v[132:135]
    buffer_load_dwordx4 a[44:47], v240, s[32:35], s3 offen offset:1024 sc1
    v_lshrrev_b32 v15, 16, v15
    v_mfma_f32_16x16x32_bf16 v[76:79], a[72:75], a[140:143], v[76:79]
    v_mul_u32_u24 v12, 10, v15
    v_mfma_f32_16x16x32_bf16 v[96:99], a[72:75], a[144:147], v[96:99]
    buffer_load_dwordx4 a[48:51], v240, s[32:35], s3 offen offset:2048 sc1
    v_sub_u32 v12, v13, v12
    v_mfma_f32_16x16x32_bf16 v[116:119], a[72:75], a[148:151], v[116:119]
    v_mul_u32_u24 v231, 176, v15
    v_mfma_f32_16x16x32_bf16 v[136:139], a[72:75], a[152:155], v[136:139]
    buffer_load_dwordx4 a[52:55], v240, s[32:35], s3 offen offset:3072 sc1
    v_lshl_add_u32 v231, v12, 4, v231
    v_mfma_f32_16x16x32_bf16 v[80:83], a[76:79], a[140:143], v[80:83]
    v_add_u32 v231, s68, v231
    v_mfma_f32_16x16x32_bf16 v[100:103], a[76:79], a[144:147], v[100:103]
    buffer_load_dwordx4 a[56:59], v241, s[32:35], s3 offen sc1
    v_mul_u32_u24 v15, 1280, v15
    v_mfma_f32_16x16x32_bf16 v[120:123], a[76:79], a[148:151], v[120:123]
    v_lshl_add_u32 v15, v12, 4, v15
    v_mfma_f32_16x16x32_bf16 v[140:143], a[76:79], a[152:155], v[140:143]
    s_waitcnt vmcnt(22)
    v_mfma_f32_16x16x32_bf16 v[64:67], a[80:83], a[156:159], v[64:67]
    s_mov_b32 s97, 59392
    v_mfma_f32_16x16x32_bf16 v[84:87], a[80:83], a[160:163], v[84:87]
    buffer_load_dwordx4 a[140:143], v244, s[28:31], s97 offen sc1
    v_mfma_f32_16x16x32_bf16 v[104:107], a[80:83], a[164:167], v[104:107]
    v_add_u32 v234, s69, v15
    v_mfma_f32_16x16x32_bf16 v[124:127], a[80:83], a[168:171], v[124:127]
    buffer_load_dwordx4 a[144:147], v245, s[28:31], s97 offen sc1
    v_add_u32 v13, 128, v1
    v_mfma_f32_16x16x32_bf16 v[68:71], a[84:87], a[156:159], v[68:71]
    v_mul_u32_u24 v15, 6554, v13
    v_mfma_f32_16x16x32_bf16 v[88:91], a[84:87], a[160:163], v[88:91]
    buffer_load_dwordx4 a[148:151], v246, s[28:31], s97 offen sc1
    v_lshrrev_b32 v15, 16, v15
    v_mfma_f32_16x16x32_bf16 v[108:111], a[84:87], a[164:167], v[108:111]
    v_mul_u32_u24 v12, 10, v15
    v_mfma_f32_16x16x32_bf16 v[128:131], a[84:87], a[168:171], v[128:131]
    buffer_load_dwordx4 a[152:155], v247, s[28:31], s97 offen sc1
    v_sub_u32 v12, v13, v12
    v_mfma_f32_16x16x32_bf16 v[72:75], a[88:91], a[156:159], v[72:75]
    s_mov_b32 s3, 2703360
    v_mul_u32_u24 v232, 176, v15
    v_mfma_f32_16x16x32_bf16 v[92:95], a[88:91], a[160:163], v[92:95]
    buffer_load_dwordx4 a[60:63], v240, s[32:35], s3 offen sc1
    v_lshl_add_u32 v232, v12, 4, v232
    v_mfma_f32_16x16x32_bf16 v[112:115], a[88:91], a[164:167], v[112:115]
    v_add_u32 v232, s68, v232
    v_mfma_f32_16x16x32_bf16 v[132:135], a[88:91], a[168:171], v[132:135]
    buffer_load_dwordx4 a[64:67], v240, s[32:35], s3 offen offset:1024 sc1
    v_mul_u32_u24 v15, 1280, v15
    v_mfma_f32_16x16x32_bf16 v[76:79], a[92:95], a[156:159], v[76:79]
    v_lshl_add_u32 v15, v12, 4, v15
    v_mfma_f32_16x16x32_bf16 v[96:99], a[92:95], a[160:163], v[96:99]
    buffer_load_dwordx4 a[68:71], v240, s[32:35], s3 offen offset:2048 sc1
    v_add_u32 v235, s69, v15
    v_mfma_f32_16x16x32_bf16 v[116:119], a[92:95], a[164:167], v[116:119]
    v_cmp_gt_u32 vcc, 160, v13
    v_mfma_f32_16x16x32_bf16 v[136:139], a[92:95], a[168:171], v[136:139]
    buffer_load_dwordx4 a[72:75], v240, s[32:35], s3 offen offset:3072 sc1
    s_nop 1
    v_mfma_f32_16x16x32_bf16 v[80:83], a[96:99], a[156:159], v[80:83]
    v_cndmask_b32 v235, -1, v235, vcc
    v_mfma_f32_16x16x32_bf16 v[100:103], a[96:99], a[160:163], v[100:103]
    buffer_load_dwordx4 a[76:79], v241, s[32:35], s3 offen sc1
    v_cndmask_b32 v232, 0, v232, vcc
    v_mfma_f32_16x16x32_bf16 v[120:123], a[96:99], a[164:167], v[120:123]
    v_mfma_f32_16x16x32_bf16 v[140:143], a[96:99], a[168:171], v[140:143]
    s_waitcnt vmcnt(27)
    s_barrier
    v_mfma_f32_16x16x32_bf16 v[64:67], a[100:103], a[172:175], v[64:67]
    s_mov_b32 s97, 63488
    v_mfma_f32_16x16x32_bf16 v[84:87], a[100:103], a[176:179], v[84:87]
    buffer_load_dwordx4 a[156:159], v244, s[28:31], s97 offen sc1
    v_mfma_f32_16x16x32_bf16 v[104:107], a[100:103], a[180:183], v[104:107]
    v_mfma_f32_16x16x32_bf16 v[124:127], a[100:103], a[184:187], v[124:127]
    buffer_load_dwordx4 a[160:163], v245, s[28:31], s97 offen sc1
    v_mfma_f32_16x16x32_bf16 v[68:71], a[104:107], a[172:175], v[68:71]
    v_mfma_f32_16x16x32_bf16 v[88:91], a[104:107], a[176:179], v[88:91]
    buffer_load_dwordx4 a[164:167], v246, s[28:31], s97 offen sc1
    v_mfma_f32_16x16x32_bf16 v[108:111], a[104:107], a[180:183], v[108:111]
    v_mfma_f32_16x16x32_bf16 v[128:131], a[104:107], a[184:187], v[128:131]
    buffer_load_dwordx4 a[168:171], v247, s[28:31], s97 offen sc1
    v_mfma_f32_16x16x32_bf16 v[72:75], a[108:111], a[172:175], v[72:75]
    s_mov_b32 s3, 2867200
    v_mfma_f32_16x16x32_bf16 v[92:95], a[108:111], a[176:179], v[92:95]
    buffer_load_dwordx4 a[80:83], v240, s[32:35], s3 offen sc1
    v_mfma_f32_16x16x32_bf16 v[112:115], a[108:111], a[180:183], v[112:115]
    v_mfma_f32_16x16x32_bf16 v[132:135], a[108:111], a[184:187], v[132:135]
    buffer_load_dwordx4 a[84:87], v240, s[32:35], s3 offen offset:1024 sc1
    v_mfma_f32_16x16x32_bf16 v[76:79], a[112:115], a[172:175], v[76:79]
    v_mfma_f32_16x16x32_bf16 v[96:99], a[112:115], a[176:179], v[96:99]
    buffer_load_dwordx4 a[88:91], v240, s[32:35], s3 offen offset:2048 sc1
    v_mfma_f32_16x16x32_bf16 v[116:119], a[112:115], a[180:183], v[116:119]
    v_mfma_f32_16x16x32_bf16 v[136:139], a[112:115], a[184:187], v[136:139]
    buffer_load_dwordx4 a[92:95], v240, s[32:35], s3 offen offset:3072 sc1
    v_mfma_f32_16x16x32_bf16 v[80:83], a[116:119], a[172:175], v[80:83]
    v_mfma_f32_16x16x32_bf16 v[100:103], a[116:119], a[176:179], v[100:103]
    buffer_load_dwordx4 a[96:99], v241, s[32:35], s3 offen sc1
    v_mfma_f32_16x16x32_bf16 v[120:123], a[116:119], a[180:183], v[120:123]
    v_mfma_f32_16x16x32_bf16 v[140:143], a[116:119], a[184:187], v[140:143]
    s_waitcnt vmcnt(32)
    v_mfma_f32_16x16x32_bf16 v[64:67], a[120:123], a[188:191], v[64:67]
    s_mov_b32 s97, 67584
    v_mfma_f32_16x16x32_bf16 v[84:87], a[120:123], a[192:195], v[84:87]
    buffer_load_dwordx4 a[172:175], v244, s[28:31], s97 offen sc1
    v_mfma_f32_16x16x32_bf16 v[104:107], a[120:123], a[196:199], v[104:107]
    v_mfma_f32_16x16x32_bf16 v[124:127], a[120:123], a[200:203], v[124:127]
    v_mfma_f32_16x16x32_bf16 v[68:71], a[124:127], a[188:191], v[68:71]
    v_mfma_f32_16x16x32_bf16 v[88:91], a[124:127], a[192:195], v[88:91]
    buffer_load_dwordx4 a[176:179], v245, s[28:31], s97 offen sc1
    v_mfma_f32_16x16x32_bf16 v[108:111], a[124:127], a[196:199], v[108:111]
    v_mfma_f32_16x16x32_bf16 v[128:131], a[124:127], a[200:203], v[128:131]
    v_mfma_f32_16x16x32_bf16 v[72:75], a[128:131], a[188:191], v[72:75]
    v_mfma_f32_16x16x32_bf16 v[92:95], a[128:131], a[192:195], v[92:95]
    v_mfma_f32_16x16x32_bf16 v[112:115], a[128:131], a[196:199], v[112:115]
    buffer_load_dwordx4 a[180:183], v246, s[28:31], s97 offen sc1
    v_mfma_f32_16x16x32_bf16 v[132:135], a[128:131], a[200:203], v[132:135]
    v_mfma_f32_16x16x32_bf16 v[76:79], a[132:135], a[188:191], v[76:79]
    v_mfma_f32_16x16x32_bf16 v[96:99], a[132:135], a[192:195], v[96:99]
    v_mfma_f32_16x16x32_bf16 v[116:119], a[132:135], a[196:199], v[116:119]
    buffer_load_dwordx4 a[184:187], v247, s[28:31], s97 offen sc1
    v_mfma_f32_16x16x32_bf16 v[136:139], a[132:135], a[200:203], v[136:139]
    v_mfma_f32_16x16x32_bf16 v[80:83], a[136:139], a[188:191], v[80:83]
    v_mfma_f32_16x16x32_bf16 v[100:103], a[136:139], a[192:195], v[100:103]
    v_mfma_f32_16x16x32_bf16 v[120:123], a[136:139], a[196:199], v[120:123]
    v_mfma_f32_16x16x32_bf16 v[140:143], a[136:139], a[200:203], v[140:143]
    s_waitcnt vmcnt(27)
    v_mfma_f32_16x16x32_bf16 v[144:147], a[0:3], a[204:207], v[144:147]
    s_mov_b32 s97, 71680
    v_sub_f32 v52, 1.0, v16
    v_lshlrev_b32 v42, 16, v26
    v_mfma_f32_16x16x32_bf16 v[164:167], a[0:3], a[208:211], v[164:167]
    buffer_load_dwordx2 a[188:189], v60, s[28:31], s97 offen sc1
    v_sub_f32 v53, 1.0, v16
    v_and_b32 v43, 0xffff0000, v26
    v_mfma_f32_16x16x32_bf16 v[184:187], a[0:3], a[212:215], v[184:187]
    v_sub_f32 v54, 1.0, v17
    v_lshlrev_b32 v44, 16, v27
    v_mfma_f32_16x16x32_bf16 v[204:207], a[0:3], a[216:219], v[204:207]
    buffer_load_dwordx2 a[190:191], v60, s[28:31], s97 offen offset:512 sc1
    v_sub_f32 v55, 1.0, v17
    v_and_b32 v45, 0xffff0000, v27
    v_mfma_f32_16x16x32_bf16 v[148:151], a[4:7], a[204:207], v[148:151]
    v_sub_f32 v56, 1.0, v18
    v_lshlrev_b32 v46, 16, v28
    v_mfma_f32_16x16x32_bf16 v[168:171], a[4:7], a[208:211], v[168:171]
    buffer_load_dwordx2 a[192:193], v61, s[28:31], s97 offen sc1
    v_sub_f32 v57, 1.0, v18
    v_and_b32 v47, 0xffff0000, v28
    v_mfma_f32_16x16x32_bf16 v[188:191], a[4:7], a[212:215], v[188:191]
    v_sub_f32 v58, 1.0, v19
    v_lshlrev_b32 v48, 16, v29
    v_mfma_f32_16x16x32_bf16 v[208:211], a[4:7], a[216:219], v[208:211]
    buffer_load_dwordx2 a[194:195], v61, s[28:31], s97 offen offset:512 sc1
    v_sub_f32 v59, 1.0, v19
    v_and_b32 v49, 0xffff0000, v29
    v_mfma_f32_16x16x32_bf16 v[152:155], a[8:11], a[204:207], v[152:155]
    v_lshlrev_b32 v30, 16, v20
    v_mov_b32 v4, v16
    v_mfma_f32_16x16x32_bf16 v[172:175], a[8:11], a[208:211], v[172:175]
    v_and_b32 v31, 0xffff0000, v20
    v_mov_b32 v5, v16
    v_mfma_f32_16x16x32_bf16 v[192:195], a[8:11], a[212:215], v[192:195]
    buffer_load_dwordx2 a[196:197], v62, s[28:31], s97 offen sc1
    v_lshlrev_b32 v32, 16, v21
    v_mov_b32 v6, v17
    v_mfma_f32_16x16x32_bf16 v[212:215], a[8:11], a[216:219], v[212:215]
    v_and_b32 v33, 0xffff0000, v21
    v_mov_b32 v7, v17
    v_mfma_f32_16x16x32_bf16 v[156:159], a[12:15], a[204:207], v[156:159]
    buffer_load_dwordx2 a[198:199], v62, s[28:31], s97 offen offset:512 sc1
    v_lshlrev_b32 v34, 16, v22
    v_mov_b32 v8, v18
    v_mfma_f32_16x16x32_bf16 v[176:179], a[12:15], a[208:211], v[176:179]
    v_and_b32 v35, 0xffff0000, v22
    v_mov_b32 v9, v18
    v_mfma_f32_16x16x32_bf16 v[196:199], a[12:15], a[212:215], v[196:199]
    buffer_load_dwordx2 a[200:201], v63, s[28:31], s97 offen sc1
    v_lshlrev_b32 v36, 16, v23
    v_mov_b32 v10, v19
    v_mfma_f32_16x16x32_bf16 v[216:219], a[12:15], a[216:219], v[216:219]
    v_and_b32 v37, 0xffff0000, v23
    v_mov_b32 v11, v19
    v_mfma_f32_16x16x32_bf16 v[160:163], a[16:19], a[204:207], v[160:163]
    buffer_load_dwordx2 a[202:203], v63, s[28:31], s97 offen offset:512 sc1
    v_lshlrev_b32 v38, 16, v24
    v_mfma_f32_16x16x32_bf16 v[180:183], a[16:19], a[208:211], v[180:183]
    v_and_b32 v39, 0xffff0000, v24
    v_mfma_f32_16x16x32_bf16 v[200:203], a[16:19], a[212:215], v[200:203]
    v_lshlrev_b32 v40, 16, v25
    v_mfma_f32_16x16x32_bf16 v[220:223], a[16:19], a[216:219], v[220:223]
    v_and_b32 v41, 0xffff0000, v25
    s_waitcnt vmcnt(26)
    v_mfma_f32_16x16x32_bf16 v[144:147], a[20:23], a[140:143], v[144:147]
    v_mul_f32 v64, v64, v52
    v_mfma_f32_16x16x32_bf16 v[164:167], a[20:23], a[144:147], v[164:167]
    v_mul_f32 v65, v65, v52
    v_mfma_f32_16x16x32_bf16 v[184:187], a[20:23], a[148:151], v[184:187]
    v_mul_f32 v66, v66, v52
    v_mfma_f32_16x16x32_bf16 v[204:207], a[20:23], a[152:155], v[204:207]
    v_mul_f32 v67, v67, v52
    v_mfma_f32_16x16x32_bf16 v[148:151], a[24:27], a[140:143], v[148:151]
    v_mul_f32 v68, v68, v52
    v_mfma_f32_16x16x32_bf16 v[168:171], a[24:27], a[144:147], v[168:171]
    v_mul_f32 v69, v69, v52
    v_mfma_f32_16x16x32_bf16 v[188:191], a[24:27], a[148:151], v[188:191]
    v_mul_f32 v70, v70, v52
    v_mfma_f32_16x16x32_bf16 v[208:211], a[24:27], a[152:155], v[208:211]
    v_mul_f32 v71, v71, v52
    v_mfma_f32_16x16x32_bf16 v[152:155], a[28:31], a[140:143], v[152:155]
    v_mul_f32 v72, v72, v52
    v_mfma_f32_16x16x32_bf16 v[172:175], a[28:31], a[144:147], v[172:175]
    v_mul_f32 v73, v73, v52
    v_mfma_f32_16x16x32_bf16 v[192:195], a[28:31], a[148:151], v[192:195]
    v_mul_f32 v74, v74, v52
    v_mfma_f32_16x16x32_bf16 v[212:215], a[28:31], a[152:155], v[212:215]
    v_mul_f32 v75, v75, v52
    v_mfma_f32_16x16x32_bf16 v[156:159], a[32:35], a[140:143], v[156:159]
    v_mul_f32 v76, v76, v52
    v_mfma_f32_16x16x32_bf16 v[176:179], a[32:35], a[144:147], v[176:179]
    v_mul_f32 v77, v77, v52
    v_mfma_f32_16x16x32_bf16 v[196:199], a[32:35], a[148:151], v[196:199]
    v_mul_f32 v78, v78, v52
    v_mfma_f32_16x16x32_bf16 v[216:219], a[32:35], a[152:155], v[216:219]
    v_mul_f32 v79, v79, v52
    v_mfma_f32_16x16x32_bf16 v[160:163], a[36:39], a[140:143], v[160:163]
    v_mul_f32 v80, v80, v52
    v_mfma_f32_16x16x32_bf16 v[180:183], a[36:39], a[144:147], v[180:183]
    v_mul_f32 v81, v81, v52
    v_mfma_f32_16x16x32_bf16 v[200:203], a[36:39], a[148:151], v[200:203]
    v_mul_f32 v82, v82, v52
    v_mfma_f32_16x16x32_bf16 v[220:223], a[36:39], a[152:155], v[220:223]
    v_mul_f32 v83, v83, v52
    s_waitcnt vmcnt(17)
    v_mfma_f32_16x16x32_bf16 v[144:147], a[40:43], a[156:159], v[144:147]
    v_mul_f32 v84, v84, v54
    v_mfma_f32_16x16x32_bf16 v[164:167], a[40:43], a[160:163], v[164:167]
    v_mul_f32 v85, v85, v54
    v_mfma_f32_16x16x32_bf16 v[184:187], a[40:43], a[164:167], v[184:187]
    v_mul_f32 v86, v86, v54
    v_mfma_f32_16x16x32_bf16 v[204:207], a[40:43], a[168:171], v[204:207]
    v_mul_f32 v87, v87, v54
    v_mfma_f32_16x16x32_bf16 v[148:151], a[44:47], a[156:159], v[148:151]
    v_mul_f32 v88, v88, v54
    v_mfma_f32_16x16x32_bf16 v[168:171], a[44:47], a[160:163], v[168:171]
    v_mul_f32 v89, v89, v54
    v_mfma_f32_16x16x32_bf16 v[188:191], a[44:47], a[164:167], v[188:191]
    v_mul_f32 v90, v90, v54
    v_mfma_f32_16x16x32_bf16 v[208:211], a[44:47], a[168:171], v[208:211]
    v_mul_f32 v91, v91, v54
    v_mfma_f32_16x16x32_bf16 v[152:155], a[48:51], a[156:159], v[152:155]
    v_mul_f32 v92, v92, v54
    v_mfma_f32_16x16x32_bf16 v[172:175], a[48:51], a[160:163], v[172:175]
    v_mul_f32 v93, v93, v54
    v_mfma_f32_16x16x32_bf16 v[192:195], a[48:51], a[164:167], v[192:195]
    v_mul_f32 v94, v94, v54
    v_mfma_f32_16x16x32_bf16 v[212:215], a[48:51], a[168:171], v[212:215]
    v_mul_f32 v95, v95, v54
    v_mfma_f32_16x16x32_bf16 v[156:159], a[52:55], a[156:159], v[156:159]
    v_mul_f32 v96, v96, v54
    v_mfma_f32_16x16x32_bf16 v[176:179], a[52:55], a[160:163], v[176:179]
    v_mul_f32 v97, v97, v54
    v_mfma_f32_16x16x32_bf16 v[196:199], a[52:55], a[164:167], v[196:199]
    v_mul_f32 v98, v98, v54
    v_mfma_f32_16x16x32_bf16 v[216:219], a[52:55], a[168:171], v[216:219]
    v_mul_f32 v99, v99, v54
    v_mfma_f32_16x16x32_bf16 v[160:163], a[56:59], a[156:159], v[160:163]
    v_mul_f32 v100, v100, v54
    v_mfma_f32_16x16x32_bf16 v[180:183], a[56:59], a[160:163], v[180:183]
    v_mul_f32 v101, v101, v54
    v_mfma_f32_16x16x32_bf16 v[200:203], a[56:59], a[164:167], v[200:203]
    v_mul_f32 v102, v102, v54
    v_mfma_f32_16x16x32_bf16 v[220:223], a[56:59], a[168:171], v[220:223]
    v_mul_f32 v103, v103, v54
    s_waitcnt vmcnt(8)
    v_mfma_f32_16x16x32_bf16 v[144:147], a[60:63], a[172:175], v[144:147]
    v_mul_f32 v104, v104, v56
    v_mfma_f32_16x16x32_bf16 v[164:167], a[60:63], a[176:179], v[164:167]
    v_mul_f32 v105, v105, v56
    v_mfma_f32_16x16x32_bf16 v[184:187], a[60:63], a[180:183], v[184:187]
    v_mul_f32 v106, v106, v56
    v_mfma_f32_16x16x32_bf16 v[204:207], a[60:63], a[184:187], v[204:207]
    v_mul_f32 v107, v107, v56
    v_mfma_f32_16x16x32_bf16 v[148:151], a[64:67], a[172:175], v[148:151]
    v_mul_f32 v108, v108, v56
    v_mfma_f32_16x16x32_bf16 v[168:171], a[64:67], a[176:179], v[168:171]
    v_mul_f32 v109, v109, v56
    v_mfma_f32_16x16x32_bf16 v[188:191], a[64:67], a[180:183], v[188:191]
    v_mul_f32 v110, v110, v56
    v_mfma_f32_16x16x32_bf16 v[208:211], a[64:67], a[184:187], v[208:211]
    v_mul_f32 v111, v111, v56
    v_mfma_f32_16x16x32_bf16 v[152:155], a[68:71], a[172:175], v[152:155]
    v_mul_f32 v112, v112, v56
    v_mfma_f32_16x16x32_bf16 v[172:175], a[68:71], a[176:179], v[172:175]
    v_mul_f32 v113, v113, v56
    v_mfma_f32_16x16x32_bf16 v[192:195], a[68:71], a[180:183], v[192:195]
    v_mul_f32 v114, v114, v56
    v_mfma_f32_16x16x32_bf16 v[212:215], a[68:71], a[184:187], v[212:215]
    v_mul_f32 v115, v115, v56
    v_mfma_f32_16x16x32_bf16 v[156:159], a[72:75], a[172:175], v[156:159]
    v_mul_f32 v116, v116, v56
    v_mfma_f32_16x16x32_bf16 v[176:179], a[72:75], a[176:179], v[176:179]
    v_mul_f32 v117, v117, v56
    v_mfma_f32_16x16x32_bf16 v[196:199], a[72:75], a[180:183], v[196:199]
    v_mul_f32 v118, v118, v56
    v_mfma_f32_16x16x32_bf16 v[216:219], a[72:75], a[184:187], v[216:219]
    v_mul_f32 v119, v119, v56
    v_mfma_f32_16x16x32_bf16 v[160:163], a[76:79], a[172:175], v[160:163]
    v_mul_f32 v120, v120, v56
    v_mfma_f32_16x16x32_bf16 v[180:183], a[76:79], a[176:179], v[180:183]
    v_mul_f32 v121, v121, v56
    v_mfma_f32_16x16x32_bf16 v[200:203], a[76:79], a[180:183], v[200:203]
    v_mul_f32 v122, v122, v56
    v_mfma_f32_16x16x32_bf16 v[220:223], a[76:79], a[184:187], v[220:223]
    v_mul_f32 v123, v123, v56
    s_waitcnt vmcnt(0)
    v_mfma_f32_16x16x32_bf16 v[144:147], a[80:83], a[188:191], v[144:147]
    v_mul_f32 v124, v124, v58
    v_mfma_f32_16x16x32_bf16 v[164:167], a[80:83], a[192:195], v[164:167]
    v_mul_f32 v125, v125, v58
    v_mfma_f32_16x16x32_bf16 v[184:187], a[80:83], a[196:199], v[184:187]
    v_mul_f32 v126, v126, v58
    v_mfma_f32_16x16x32_bf16 v[204:207], a[80:83], a[200:203], v[204:207]
    v_mul_f32 v127, v127, v58
    v_mfma_f32_16x16x32_bf16 v[148:151], a[84:87], a[188:191], v[148:151]
    v_mul_f32 v128, v128, v58
    v_mfma_f32_16x16x32_bf16 v[168:171], a[84:87], a[192:195], v[168:171]
    v_mul_f32 v129, v129, v58
    v_mfma_f32_16x16x32_bf16 v[188:191], a[84:87], a[196:199], v[188:191]
    v_mul_f32 v130, v130, v58
    v_mfma_f32_16x16x32_bf16 v[208:211], a[84:87], a[200:203], v[208:211]
    v_mul_f32 v131, v131, v58
    v_mfma_f32_16x16x32_bf16 v[152:155], a[88:91], a[188:191], v[152:155]
    v_mul_f32 v132, v132, v58
    v_mfma_f32_16x16x32_bf16 v[172:175], a[88:91], a[192:195], v[172:175]
    v_mul_f32 v133, v133, v58
    v_mfma_f32_16x16x32_bf16 v[192:195], a[88:91], a[196:199], v[192:195]
    v_mul_f32 v134, v134, v58
    v_mfma_f32_16x16x32_bf16 v[212:215], a[88:91], a[200:203], v[212:215]
    v_mul_f32 v135, v135, v58
    v_mfma_f32_16x16x32_bf16 v[156:159], a[92:95], a[188:191], v[156:159]
    v_mul_f32 v136, v136, v58
    v_mfma_f32_16x16x32_bf16 v[176:179], a[92:95], a[192:195], v[176:179]
    v_mul_f32 v137, v137, v58
    v_mfma_f32_16x16x32_bf16 v[196:199], a[92:95], a[196:199], v[196:199]
    v_mul_f32 v138, v138, v58
    v_mfma_f32_16x16x32_bf16 v[216:219], a[92:95], a[200:203], v[216:219]
    v_mul_f32 v139, v139, v58
    v_mfma_f32_16x16x32_bf16 v[160:163], a[96:99], a[188:191], v[160:163]
    v_mul_f32 v140, v140, v58
    v_mfma_f32_16x16x32_bf16 v[180:183], a[96:99], a[192:195], v[180:183]
    v_mul_f32 v141, v141, v58
    v_mfma_f32_16x16x32_bf16 v[200:203], a[96:99], a[196:199], v[200:203]
    v_mul_f32 v142, v142, v58
    v_mfma_f32_16x16x32_bf16 v[220:223], a[96:99], a[200:203], v[220:223]
    v_mul_f32 v143, v143, v58
    s_cmp_lg_u32 s50, 0
    s_cbranch_scc1 L_p2_red_skip0
    v_pk_fma_f32 v[164:165], v[164:165], v[6:7], v[84:85]
    v_pk_fma_f32 v[166:167], v[166:167], v[6:7], v[86:87]
    v_pk_fma_f32 v[168:169], v[168:169], v[6:7], v[88:89]
    v_pk_fma_f32 v[170:171], v[170:171], v[6:7], v[90:91]
    v_pk_fma_f32 v[172:173], v[172:173], v[6:7], v[92:93]
    v_pk_fma_f32 v[174:175], v[174:175], v[6:7], v[94:95]
    ds_write_b128 v224, v[164:167] offset:20480
    v_pk_fma_f32 v[176:177], v[176:177], v[6:7], v[96:97]
    v_pk_fma_f32 v[178:179], v[178:179], v[6:7], v[98:99]
    ds_write_b128 v224, v[168:171] offset:21504
    v_pk_fma_f32 v[180:181], v[180:181], v[6:7], v[100:101]
    v_pk_fma_f32 v[182:183], v[182:183], v[6:7], v[102:103]
    ds_write_b128 v224, v[172:175] offset:22528
    v_pk_fma_f32 v[184:185], v[184:185], v[8:9], v[104:105]
    v_pk_fma_f32 v[186:187], v[186:187], v[8:9], v[106:107]
    ds_write_b128 v224, v[176:179] offset:23552
    v_pk_fma_f32 v[188:189], v[188:189], v[8:9], v[108:109]
    v_pk_fma_f32 v[190:191], v[190:191], v[8:9], v[110:111]
    ds_write_b128 v224, v[180:183] offset:24576
    v_pk_fma_f32 v[192:193], v[192:193], v[8:9], v[112:113]
    v_pk_fma_f32 v[194:195], v[194:195], v[8:9], v[114:115]
    ds_write_b128 v225, v[184:187] offset:0
    v_pk_fma_f32 v[196:197], v[196:197], v[8:9], v[116:117]
    v_pk_fma_f32 v[198:199], v[198:199], v[8:9], v[118:119]
    ds_write_b128 v225, v[188:191] offset:1024
    v_pk_fma_f32 v[200:201], v[200:201], v[8:9], v[120:121]
    v_pk_fma_f32 v[202:203], v[202:203], v[8:9], v[122:123]
    ds_write_b128 v225, v[192:195] offset:2048
    v_pk_fma_f32 v[204:205], v[204:205], v[10:11], v[124:125]
    v_pk_fma_f32 v[206:207], v[206:207], v[10:11], v[126:127]
    ds_write_b128 v225, v[196:199] offset:3072
    v_pk_fma_f32 v[208:209], v[208:209], v[10:11], v[128:129]
    v_pk_fma_f32 v[210:211], v[210:211], v[10:11], v[130:131]
    ds_write_b128 v225, v[200:203] offset:4096
    v_pk_fma_f32 v[212:213], v[212:213], v[10:11], v[132:133]
    v_pk_fma_f32 v[214:215], v[214:215], v[10:11], v[134:135]
    ds_write_b128 v225, v[204:207] offset:20480
    v_pk_fma_f32 v[216:217], v[216:217], v[10:11], v[136:137]
    v_pk_fma_f32 v[218:219], v[218:219], v[10:11], v[138:139]
    ds_write_b128 v225, v[208:211] offset:21504
    v_pk_fma_f32 v[220:221], v[220:221], v[10:11], v[140:141]
    v_pk_fma_f32 v[222:223], v[222:223], v[10:11], v[142:143]
    ds_write_b128 v225, v[212:215] offset:22528
    ds_write_b128 v225, v[216:219] offset:23552
    ds_write_b128 v225, v[220:223] offset:24576
    v_pk_fma_f32 v[144:145], v[144:145], v[4:5], v[64:65]
    v_pk_fma_f32 v[146:147], v[146:147], v[4:5], v[66:67]
    v_pk_fma_f32 v[148:149], v[148:149], v[4:5], v[68:69]
    v_pk_fma_f32 v[150:151], v[150:151], v[4:5], v[70:71]
    v_pk_fma_f32 v[152:153], v[152:153], v[4:5], v[72:73]
    v_pk_fma_f32 v[154:155], v[154:155], v[4:5], v[74:75]
    v_pk_fma_f32 v[156:157], v[156:157], v[4:5], v[76:77]
    v_pk_fma_f32 v[158:159], v[158:159], v[4:5], v[78:79]
    v_pk_fma_f32 v[160:161], v[160:161], v[4:5], v[80:81]
    v_pk_fma_f32 v[162:163], v[162:163], v[4:5], v[82:83]
    v_pk_fma_f32 v[236:237], v[30:31], v[52:53], v[144:145]
    v_pk_fma_f32 v[238:239], v[32:33], v[52:53], v[146:147]
    v_pk_fma_f32 v[240:241], v[34:35], v[52:53], v[148:149]
    v_pk_fma_f32 v[242:243], v[36:37], v[52:53], v[150:151]
    v_pk_fma_f32 v[244:245], v[38:39], v[52:53], v[152:153]
    v_pk_fma_f32 v[246:247], v[40:41], v[52:53], v[154:155]
    v_pk_fma_f32 v[248:249], v[42:43], v[52:53], v[156:157]
    v_pk_fma_f32 v[250:251], v[44:45], v[52:53], v[158:159]
    v_pk_fma_f32 v[252:253], v[46:47], v[52:53], v[160:161]
    v_pk_fma_f32 v[254:255], v[48:49], v[52:53], v[162:163]
    s_branch L_p2_red_done
L_p2_red_skip0:
    s_cmp_lg_u32 s50, 1
    s_cbranch_scc1 L_p2_red_skip1
    v_pk_fma_f32 v[184:185], v[184:185], v[8:9], v[104:105]
    v_pk_fma_f32 v[186:187], v[186:187], v[8:9], v[106:107]
    v_pk_fma_f32 v[188:189], v[188:189], v[8:9], v[108:109]
    v_pk_fma_f32 v[190:191], v[190:191], v[8:9], v[110:111]
    v_pk_fma_f32 v[192:193], v[192:193], v[8:9], v[112:113]
    v_pk_fma_f32 v[194:195], v[194:195], v[8:9], v[114:115]
    ds_write_b128 v225, v[184:187] offset:0
    v_pk_fma_f32 v[196:197], v[196:197], v[8:9], v[116:117]
    v_pk_fma_f32 v[198:199], v[198:199], v[8:9], v[118:119]
    ds_write_b128 v225, v[188:191] offset:1024
    v_pk_fma_f32 v[200:201], v[200:201], v[8:9], v[120:121]
    v_pk_fma_f32 v[202:203], v[202:203], v[8:9], v[122:123]
    ds_write_b128 v225, v[192:195] offset:2048
    v_pk_fma_f32 v[204:205], v[204:205], v[10:11], v[124:125]
    v_pk_fma_f32 v[206:207], v[206:207], v[10:11], v[126:127]
    ds_write_b128 v225, v[196:199] offset:3072
    v_pk_fma_f32 v[208:209], v[208:209], v[10:11], v[128:129]
    v_pk_fma_f32 v[210:211], v[210:211], v[10:11], v[130:131]
    ds_write_b128 v225, v[200:203] offset:4096
    v_pk_fma_f32 v[212:213], v[212:213], v[10:11], v[132:133]
    v_pk_fma_f32 v[214:215], v[214:215], v[10:11], v[134:135]
    ds_write_b128 v225, v[204:207] offset:20480
    v_pk_fma_f32 v[216:217], v[216:217], v[10:11], v[136:137]
    v_pk_fma_f32 v[218:219], v[218:219], v[10:11], v[138:139]
    ds_write_b128 v225, v[208:211] offset:21504
    v_pk_fma_f32 v[220:221], v[220:221], v[10:11], v[140:141]
    v_pk_fma_f32 v[222:223], v[222:223], v[10:11], v[142:143]
    ds_write_b128 v225, v[212:215] offset:22528
    v_pk_fma_f32 v[144:145], v[144:145], v[4:5], v[64:65]
    v_pk_fma_f32 v[146:147], v[146:147], v[4:5], v[66:67]
    ds_write_b128 v225, v[216:219] offset:23552
    v_pk_fma_f32 v[148:149], v[148:149], v[4:5], v[68:69]
    v_pk_fma_f32 v[150:151], v[150:151], v[4:5], v[70:71]
    ds_write_b128 v225, v[220:223] offset:24576
    v_pk_fma_f32 v[152:153], v[152:153], v[4:5], v[72:73]
    v_pk_fma_f32 v[154:155], v[154:155], v[4:5], v[74:75]
    ds_write_b128 v224, v[144:147] offset:0
    v_pk_fma_f32 v[156:157], v[156:157], v[4:5], v[76:77]
    v_pk_fma_f32 v[158:159], v[158:159], v[4:5], v[78:79]
    ds_write_b128 v224, v[148:151] offset:1024
    v_pk_fma_f32 v[160:161], v[160:161], v[4:5], v[80:81]
    v_pk_fma_f32 v[162:163], v[162:163], v[4:5], v[82:83]
    ds_write_b128 v224, v[152:155] offset:2048
    ds_write_b128 v224, v[156:159] offset:3072
    ds_write_b128 v224, v[160:163] offset:4096
    v_pk_fma_f32 v[164:165], v[164:165], v[6:7], v[84:85]
    v_pk_fma_f32 v[166:167], v[166:167], v[6:7], v[86:87]
    v_pk_fma_f32 v[168:169], v[168:169], v[6:7], v[88:89]
    v_pk_fma_f32 v[170:171], v[170:171], v[6:7], v[90:91]
    v_pk_fma_f32 v[172:173], v[172:173], v[6:7], v[92:93]
    v_pk_fma_f32 v[174:175], v[174:175], v[6:7], v[94:95]
    v_pk_fma_f32 v[176:177], v[176:177], v[6:7], v[96:97]
    v_pk_fma_f32 v[178:179], v[178:179], v[6:7], v[98:99]
    v_pk_fma_f32 v[180:181], v[180:181], v[6:7], v[100:101]
    v_pk_fma_f32 v[182:183], v[182:183], v[6:7], v[102:103]
    v_pk_fma_f32 v[236:237], v[30:31], v[54:55], v[164:165]
    v_pk_fma_f32 v[238:239], v[32:33], v[54:55], v[166:167]
    v_pk_fma_f32 v[240:241], v[34:35], v[54:55], v[168:169]
    v_pk_fma_f32 v[242:243], v[36:37], v[54:55], v[170:171]
    v_pk_fma_f32 v[244:245], v[38:39], v[54:55], v[172:173]
    v_pk_fma_f32 v[246:247], v[40:41], v[54:55], v[174:175]
    v_pk_fma_f32 v[248:249], v[42:43], v[54:55], v[176:177]
    v_pk_fma_f32 v[250:251], v[44:45], v[54:55], v[178:179]
    v_pk_fma_f32 v[252:253], v[46:47], v[54:55], v[180:181]
    v_pk_fma_f32 v[254:255], v[48:49], v[54:55], v[182:183]
    s_branch L_p2_red_done
L_p2_red_skip1:
    s_cmp_lg_u32 s50, 2
    s_cbranch_scc1 L_p2_red_skip2
    v_pk_fma_f32 v[204:205], v[204:205], v[10:11], v[124:125]
    v_pk_fma_f32 v[206:207], v[206:207], v[10:11], v[126:127]
    v_pk_fma_f32 v[208:209], v[208:209], v[10:11], v[128:129]
    v_pk_fma_f32 v[210:211], v[210:211], v[10:11], v[130:131]
    v_pk_fma_f32 v[212:213], v[212:213], v[10:11], v[132:133]
    v_pk_fma_f32 v[214:215], v[214:215], v[10:11], v[134:135]
    ds_write_b128 v225, v[204:207] offset:20480
    v_pk_fma_f32 v[216:217], v[216:217], v[10:11], v[136:137]
    v_pk_fma_f32 v[218:219], v[218:219], v[10:11], v[138:139]
    ds_write_b128 v225, v[208:211] offset:21504
    v_pk_fma_f32 v[220:221], v[220:221], v[10:11], v[140:141]
    v_pk_fma_f32 v[222:223], v[222:223], v[10:11], v[142:143]
    ds_write_b128 v225, v[212:215] offset:22528
    v_pk_fma_f32 v[144:145], v[144:145], v[4:5], v[64:65]
    v_pk_fma_f32 v[146:147], v[146:147], v[4:5], v[66:67]
    ds_write_b128 v225, v[216:219] offset:23552
    v_pk_fma_f32 v[148:149], v[148:149], v[4:5], v[68:69]
    v_pk_fma_f32 v[150:151], v[150:151], v[4:5], v[70:71]
    ds_write_b128 v225, v[220:223] offset:24576
    v_pk_fma_f32 v[152:153], v[152:153], v[4:5], v[72:73]
    v_pk_fma_f32 v[154:155], v[154:155], v[4:5], v[74:75]
    ds_write_b128 v224, v[144:147] offset:0
    v_pk_fma_f32 v[156:157], v[156:157], v[4:5], v[76:77]
    v_pk_fma_f32 v[158:159], v[158:159], v[4:5], v[78:79]
    ds_write_b128 v224, v[148:151] offset:1024
    v_pk_fma_f32 v[160:161], v[160:161], v[4:5], v[80:81]
    v_pk_fma_f32 v[162:163], v[162:163], v[4:5], v[82:83]
    ds_write_b128 v224, v[152:155] offset:2048
    v_pk_fma_f32 v[164:165], v[164:165], v[6:7], v[84:85]
    v_pk_fma_f32 v[166:167], v[166:167], v[6:7], v[86:87]
    ds_write_b128 v224, v[156:159] offset:3072
    v_pk_fma_f32 v[168:169], v[168:169], v[6:7], v[88:89]
    v_pk_fma_f32 v[170:171], v[170:171], v[6:7], v[90:91]
    ds_write_b128 v224, v[160:163] offset:4096
    v_pk_fma_f32 v[172:173], v[172:173], v[6:7], v[92:93]
    v_pk_fma_f32 v[174:175], v[174:175], v[6:7], v[94:95]
    ds_write_b128 v224, v[164:167] offset:20480
    v_pk_fma_f32 v[176:177], v[176:177], v[6:7], v[96:97]
    v_pk_fma_f32 v[178:179], v[178:179], v[6:7], v[98:99]
    ds_write_b128 v224, v[168:171] offset:21504
    v_pk_fma_f32 v[180:181], v[180:181], v[6:7], v[100:101]
    v_pk_fma_f32 v[182:183], v[182:183], v[6:7], v[102:103]
    ds_write_b128 v224, v[172:175] offset:22528
    ds_write_b128 v224, v[176:179] offset:23552
    ds_write_b128 v224, v[180:183] offset:24576
    v_pk_fma_f32 v[184:185], v[184:185], v[8:9], v[104:105]
    v_pk_fma_f32 v[186:187], v[186:187], v[8:9], v[106:107]
    v_pk_fma_f32 v[188:189], v[188:189], v[8:9], v[108:109]
    v_pk_fma_f32 v[190:191], v[190:191], v[8:9], v[110:111]
    v_pk_fma_f32 v[192:193], v[192:193], v[8:9], v[112:113]
    v_pk_fma_f32 v[194:195], v[194:195], v[8:9], v[114:115]
    v_pk_fma_f32 v[196:197], v[196:197], v[8:9], v[116:117]
    v_pk_fma_f32 v[198:199], v[198:199], v[8:9], v[118:119]
    v_pk_fma_f32 v[200:201], v[200:201], v[8:9], v[120:121]
    v_pk_fma_f32 v[202:203], v[202:203], v[8:9], v[122:123]
    v_pk_fma_f32 v[236:237], v[30:31], v[56:57], v[184:185]
    v_pk_fma_f32 v[238:239], v[32:33], v[56:57], v[186:187]
    v_pk_fma_f32 v[240:241], v[34:35], v[56:57], v[188:189]
    v_pk_fma_f32 v[242:243], v[36:37], v[56:57], v[190:191]
    v_pk_fma_f32 v[244:245], v[38:39], v[56:57], v[192:193]
    v_pk_fma_f32 v[246:247], v[40:41], v[56:57], v[194:195]
    v_pk_fma_f32 v[248:249], v[42:43], v[56:57], v[196:197]
    v_pk_fma_f32 v[250:251], v[44:45], v[56:57], v[198:199]
    v_pk_fma_f32 v[252:253], v[46:47], v[56:57], v[200:201]
    v_pk_fma_f32 v[254:255], v[48:49], v[56:57], v[202:203]
    s_branch L_p2_red_done
L_p2_red_skip2:
    s_cmp_lg_u32 s50, 3
    s_cbranch_scc1 L_p2_red_skip3
    v_pk_fma_f32 v[144:145], v[144:145], v[4:5], v[64:65]
    v_pk_fma_f32 v[146:147], v[146:147], v[4:5], v[66:67]
    v_pk_fma_f32 v[148:149], v[148:149], v[4:5], v[68:69]
    v_pk_fma_f32 v[150:151], v[150:151], v[4:5], v[70:71]
    v_pk_fma_f32 v[152:153], v[152:153], v[4:5], v[72:73]
    v_pk_fma_f32 v[154:155], v[154:155], v[4:5], v[74:75]
    ds_write_b128 v224, v[144:147] offset:0
    v_pk_fma_f32 v[156:157], v[156:157], v[4:5], v[76:77]
    v_pk_fma_f32 v[158:159], v[158:159], v[4:5], v[78:79]
    ds_write_b128 v224, v[148:151] offset:1024
    v_pk_fma_f32 v[160:161], v[160:161], v[4:5], v[80:81]
    v_pk_fma_f32 v[162:163], v[162:163], v[4:5], v[82:83]
    ds_write_b128 v224, v[152:155] offset:2048
    v_pk_fma_f32 v[164:165], v[164:165], v[6:7], v[84:85]
    v_pk_fma_f32 v[166:167], v[166:167], v[6:7], v[86:87]
    ds_write_b128 v224, v[156:159] offset:3072
    v_pk_fma_f32 v[168:169], v[168:169], v[6:7], v[88:89]
    v_pk_fma_f32 v[170:171], v[170:171], v[6:7], v[90:91]
    ds_write_b128 v224, v[160:163] offset:4096
    v_pk_fma_f32 v[172:173], v[172:173], v[6:7], v[92:93]
    v_pk_fma_f32 v[174:175], v[174:175], v[6:7], v[94:95]
    ds_write_b128 v224, v[164:167] offset:20480
    v_pk_fma_f32 v[176:177], v[176:177], v[6:7], v[96:97]
    v_pk_fma_f32 v[178:179], v[178:179], v[6:7], v[98:99]
    ds_write_b128 v224, v[168:171] offset:21504
    v_pk_fma_f32 v[180:181], v[180:181], v[6:7], v[100:101]
    v_pk_fma_f32 v[182:183], v[182:183], v[6:7], v[102:103]
    ds_write_b128 v224, v[172:175] offset:22528
    v_pk_fma_f32 v[184:185], v[184:185], v[8:9], v[104:105]
    v_pk_fma_f32 v[186:187], v[186:187], v[8:9], v[106:107]
    ds_write_b128 v224, v[176:179] offset:23552
    v_pk_fma_f32 v[188:189], v[188:189], v[8:9], v[108:109]
    v_pk_fma_f32 v[190:191], v[190:191], v[8:9], v[110:111]
    ds_write_b128 v224, v[180:183] offset:24576
    v_pk_fma_f32 v[192:193], v[192:193], v[8:9], v[112:113]
    v_pk_fma_f32 v[194:195], v[194:195], v[8:9], v[114:115]
    ds_write_b128 v225, v[184:187] offset:0
    v_pk_fma_f32 v[196:197], v[196:197], v[8:9], v[116:117]
    v_pk_fma_f32 v[198:199], v[198:199], v[8:9], v[118:119]
    ds_write_b128 v225, v[188:191] offset:1024
    v_pk_fma_f32 v[200:201], v[200:201], v[8:9], v[120:121]
    v_pk_fma_f32 v[202:203], v[202:203], v[8:9], v[122:123]
    ds_write_b128 v225, v[192:195] offset:2048
    ds_write_b128 v225, v[196:199] offset:3072
    ds_write_b128 v225, v[200:203] offset:4096
    v_pk_fma_f32 v[204:205], v[204:205], v[10:11], v[124:125]
    v_pk_fma_f32 v[206:207], v[206:207], v[10:11], v[126:127]
    v_pk_fma_f32 v[208:209], v[208:209], v[10:11], v[128:129]
    v_pk_fma_f32 v[210:211], v[210:211], v[10:11], v[130:131]
    v_pk_fma_f32 v[212:213], v[212:213], v[10:11], v[132:133]
    v_pk_fma_f32 v[214:215], v[214:215], v[10:11], v[134:135]
    v_pk_fma_f32 v[216:217], v[216:217], v[10:11], v[136:137]
    v_pk_fma_f32 v[218:219], v[218:219], v[10:11], v[138:139]
    v_pk_fma_f32 v[220:221], v[220:221], v[10:11], v[140:141]
    v_pk_fma_f32 v[222:223], v[222:223], v[10:11], v[142:143]
    v_pk_fma_f32 v[236:237], v[30:31], v[58:59], v[204:205]
    v_pk_fma_f32 v[238:239], v[32:33], v[58:59], v[206:207]
    v_pk_fma_f32 v[240:241], v[34:35], v[58:59], v[208:209]
    v_pk_fma_f32 v[242:243], v[36:37], v[58:59], v[210:211]
    v_pk_fma_f32 v[244:245], v[38:39], v[58:59], v[212:213]
    v_pk_fma_f32 v[246:247], v[40:41], v[58:59], v[214:215]
    v_pk_fma_f32 v[248:249], v[42:43], v[58:59], v[216:217]
    v_pk_fma_f32 v[250:251], v[44:45], v[58:59], v[218:219]
    v_pk_fma_f32 v[252:253], v[46:47], v[58:59], v[220:221]
    v_pk_fma_f32 v[254:255], v[48:49], v[58:59], v[222:223]
L_p2_red_skip3:
L_p2_red_done:
    s_waitcnt lgkmcnt(0)
    s_barrier
    ds_read_b128 v[64:67], v226 offset:0
    ds_read_b128 v[68:71], v226 offset:1024
    ds_read_b128 v[72:75], v226 offset:2048
    ds_read_b128 v[76:79], v226 offset:3072
    ds_read_b128 v[80:83], v226 offset:4096
    ds_read_b128 v[84:87], v227 offset:0
    ds_read_b128 v[88:91], v227 offset:1024
    ds_read_b128 v[92:95], v227 offset:2048
    ds_read_b128 v[96:99], v227 offset:3072
    ds_read_b128 v[100:103], v227 offset:4096
    ds_read_b128 v[104:107], v228 offset:0
    ds_read_b128 v[108:111], v228 offset:1024
    ds_read_b128 v[112:115], v228 offset:2048
    ds_read_b128 v[116:119], v228 offset:3072
    ds_read_b128 v[120:123], v228 offset:4096
    s_waitcnt lgkmcnt(10)
    v_pk_add_f32 v[236:237], v[236:237], v[64:65]
    v_pk_add_f32 v[238:239], v[238:239], v[66:67]
    v_pk_add_f32 v[240:241], v[240:241], v[68:69]
    v_pk_add_f32 v[242:243], v[242:243], v[70:71]
    v_pk_add_f32 v[244:245], v[244:245], v[72:73]
    v_pk_add_f32 v[246:247], v[246:247], v[74:75]
    v_pk_add_f32 v[248:249], v[248:249], v[76:77]
    v_pk_add_f32 v[250:251], v[250:251], v[78:79]
    v_pk_add_f32 v[252:253], v[252:253], v[80:81]
    v_pk_add_f32 v[254:255], v[254:255], v[82:83]
    s_waitcnt lgkmcnt(5)
    v_pk_add_f32 v[236:237], v[236:237], v[84:85]
    v_pk_add_f32 v[238:239], v[238:239], v[86:87]
    v_pk_add_f32 v[240:241], v[240:241], v[88:89]
    v_pk_add_f32 v[242:243], v[242:243], v[90:91]
    v_pk_add_f32 v[244:245], v[244:245], v[92:93]
    v_pk_add_f32 v[246:247], v[246:247], v[94:95]
    v_pk_add_f32 v[248:249], v[248:249], v[96:97]
    v_pk_add_f32 v[250:251], v[250:251], v[98:99]
    v_pk_add_f32 v[252:253], v[252:253], v[100:101]
    v_pk_add_f32 v[254:255], v[254:255], v[102:103]
    s_waitcnt lgkmcnt(0)
    v_pk_add_f32 v[236:237], v[236:237], v[104:105]
    v_pk_add_f32 v[238:239], v[238:239], v[106:107]
    v_pk_add_f32 v[240:241], v[240:241], v[108:109]
    v_pk_add_f32 v[242:243], v[242:243], v[110:111]
    v_pk_add_f32 v[244:245], v[244:245], v[112:113]
    v_pk_add_f32 v[246:247], v[246:247], v[114:115]
    v_pk_add_f32 v[248:249], v[248:249], v[116:117]
    v_pk_add_f32 v[250:251], v[250:251], v[118:119]
    v_pk_add_f32 v[252:253], v[252:253], v[120:121]
    v_pk_add_f32 v[254:255], v[254:255], v[122:123]
    v_cvt_pk_bf16_f32 v30, v236, v237
    v_cvt_pk_bf16_f32 v31, v238, v239
    ds_write_b64 v229, v[30:31] offset:0
    v_cvt_pk_bf16_f32 v32, v240, v241
    v_cvt_pk_bf16_f32 v33, v242, v243
    ds_write_b64 v229, v[32:33] offset:32
    v_cvt_pk_bf16_f32 v34, v244, v245
    v_cvt_pk_bf16_f32 v35, v246, v247
    ds_write_b64 v229, v[34:35] offset:64
    v_cvt_pk_bf16_f32 v36, v248, v249
    v_cvt_pk_bf16_f32 v37, v250, v251
    ds_write_b64 v229, v[36:37] offset:96
    v_cvt_pk_bf16_f32 v38, v252, v253
    v_cvt_pk_bf16_f32 v39, v254, v255
    ds_write_b64 v229, v[38:39] offset:128
    s_waitcnt lgkmcnt(0)
    ds_read_b128 v[144:147], v230
    ds_read_b128 v[148:151], v231
    ds_read_b128 v[152:155], v232
    s_waitcnt lgkmcnt(2)
    buffer_store_dwordx4 v[144:147], v233, s[44:47], 0 offen
    s_waitcnt lgkmcnt(1)
    buffer_store_dwordx4 v[148:151], v234, s[44:47], 0 offen
    s_waitcnt lgkmcnt(0)
    buffer_store_dwordx4 v[152:155], v235, s[44:47], 0 offen
L_diag_end:
L_end:
    s_endpgm
.section .rodata,"a"
.p2align 6
.amdhsa_kernel gated_mix__sliding_local_dilated__dense_activation_squared_relu__prompt_kernel
.amdhsa_next_free_vgpr 512
.amdhsa_next_free_sgpr 102
.amdhsa_accum_offset 256
.amdhsa_group_segment_fixed_size 0
.amdhsa_kernarg_size 96
.amdhsa_user_sgpr_count 2
.amdhsa_user_sgpr_kernarg_segment_ptr 1
.amdhsa_system_sgpr_workgroup_id_x 1
.end_amdhsa_kernel
.text
```
